```python
import torch

def _softmax(x, axis=-1):
    return torch.softmax(x, dim=axis)
def _gelu(x):
    return torch.nn.functional.gelu(x, approximate="tanh")
def _silu(x):
    return torch.nn.functional.silu(x)
def _sigmoid(x):
    return torch.sigmoid(x)
def _layernorm(x, axis=-1, eps=1e-5):
    m = x.mean(dim=axis, keepdim=True)
    v = x.var(dim=axis, keepdim=True, unbiased=False)
    return (x - m) / torch.sqrt(v + eps)
def _scatter_add(tgt, idx, src, axis=0):
    return tgt.clone().index_add_(axis, idx, src)
def _segment_sum(src, seg, n):
    out = torch.zeros((n,) + src.shape[1:], dtype=src.dtype)
    return out.index_add_(0, seg, src)
def _pad(x, pw):
    flat = tuple(v for pair in reversed(pw) for v in pair)
    return torch.nn.functional.pad(x, flat)

kernel_name = 'parallel_sum__mha_block_cached__geglu_ffn__decode'

def setup_inputs():

    _w = (lambda a: (lambda t: t.to(torch.bfloat16) if t.is_floating_point() else t)(torch.as_tensor(a)))
    def _A_setup():
        B, Sq, D = 1, 1, 512
        H, Sk, Dh = 32, 8192, 128
        return {
            "x": _w((lambda *s: torch.randn(*s, dtype=torch.bfloat16) * 0.05)(B, Sq, D)),
            "k_cache": _w((lambda *s: torch.randn(*s, dtype=torch.bfloat16) * 3.2)(B, H, Sk, Dh)),
            "v_cache": _w((lambda *s: torch.randn(*s, dtype=torch.bfloat16) * 1.6)(B, H, Sk, Dh)),
            "wq": _w((lambda *s: torch.randn(*s, dtype=torch.bfloat16) * 3.2)(D, H * Dh) * (D ** -0.5)),
            "wo": _w((lambda *s: torch.randn(*s, dtype=torch.bfloat16) * 1.6)(H * Dh, D) * ((H * Dh) ** -0.5)),
        }
    _A_in = _A_setup()

    def _B_setup():
        B, S, D, F = 1, 1, 512, 1376
        return {
            "x": _w((lambda *s: torch.randn(*s, dtype=torch.bfloat16) * 0.05)(B, S, D)),
            "w_gate": _w((lambda *s: torch.randn(*s, dtype=torch.bfloat16) * 0.05)(D, F)),
            "w_up": _w((lambda *s: torch.randn(*s, dtype=torch.bfloat16) * 0.05)(D, F)),
            "w_down": _w((lambda *s: torch.randn(*s, dtype=torch.bfloat16) * 0.05)(F, D)),
        }
    _B_in = _B_setup()

    return {
        "A_x": _A_in["x"],
        "A_k_cache": _A_in["k_cache"],
        "A_v_cache": _A_in["v_cache"],
        "A_wq": _A_in["wq"],
        "A_wo": _A_in["wo"],
        "B_x": _B_in["x"],
        "B_w_gate": _B_in["w_gate"],
        "B_w_up": _B_in["w_up"],
        "B_w_down": _B_in["w_down"],
    }

def reference(A_x, A_k_cache, A_v_cache, A_wq, A_wo, B_x, B_w_gate, B_w_up, B_w_down):
    def _A_ref(x, k_cache, v_cache, wq, wo):
        B, Sq, D = x.shape
        H, Dh = 32, 128
        q = (lambda x, *d: x.permute(*d))((x @ wq).reshape(B, Sq, H, Dh), 0, 2, 1, 3)
        scores = torch.einsum("bhqd,bhkd->bhqk", q, k_cache) * (Dh ** -0.5)
        p = _softmax(scores, axis=-1)
        o = torch.einsum("bhqk,bhkd->bhqd", p, v_cache)
        return (lambda x, *d: x.permute(*d))(o, 0, 2, 1, 3).reshape(B, Sq, H * Dh) @ wo

    def _B_ref(x, w_gate, w_up, w_down):
        return (_gelu(x @ w_gate) * (x @ w_up)) @ w_down

    x = A_x
    xn = _layernorm(x, axis=-1)
    return x + _A_ref(xn, A_k_cache, A_v_cache, A_wq, A_wo) + _B_ref(xn, B_w_gate, B_w_up, B_w_down)
```

```asm
; @launch grid=(256,1,1) block=(320,1,1) lds=4096
.amdgcn_target "amdgcn-amd-amdhsa--gfx950"
.text
.globl parallel_sum__mha_block_cached__geglu_ffn__decode_kernel
.p2align 8
.type parallel_sum__mha_block_cached__geglu_ffn__decode_kernel,@function
parallel_sum__mha_block_cached__geglu_ffn__decode_kernel:
    s_cmp_ge_u32 s2, 256
    s_cbranch_scc1 L_end
    s_load_dwordx16 s[4:19], s[0:1], 0
    s_load_dwordx8 s[20:27], s[0:1], 64
    v_lshrrev_b32 v1, 6, v0
    v_and_b32 v0, 63, v0
    v_readfirstlane_b32 s28, v1
    v_lshlrev_b32 v2, 4, v0
    s_and_b32 s29, s2, 7
    s_lshl_b32 s29, s29, 2
    s_lshr_b32 s79, s2, 6
    s_add_u32 s29, s29, s79
    s_lshr_b32 s30, s2, 3
    s_and_b32 s30, s30, 7
    s_mov_b32 s77, 0x3fb8aa3b
    s_cmp_eq_u32 s28, 4
    s_cbranch_scc1 L_help
L_str7:
    v_lshrrev_b32 v9, 4, v0
    v_lshlrev_b32 v10, 6, v9
    v_bfe_u32 v11, v0, 2, 2
    v_lshlrev_b32 v11, 8, v11
    v_and_b32 v15, 3, v0
    v_lshlrev_b32 v15, 4, v15
    v_add3_u32 v1, v10, v11, v15
    s_lshl_b32 s64, s30, 2
    s_add_u32 s78, s64, s28
    s_lshl_b32 s64, s78, 12
    s_mul_i32 s64, s64, 1
    s_lshl_b32 s79, s29, 21
    s_add_u32 s64, s64, s79
    s_mul_i32 s65, s29, 1
    s_waitcnt lgkmcnt(0)
    s_mov_b32 s36, s6
    s_and_b32 s37, s7, 0xffff
    s_mov_b32 s38, 0x4000000
    s_mov_b32 s39, 0x20000
    s_add_u32 s66, s65, 0
    s_and_b32 s66, s66, 15
    s_lshl_b32 s66, s66, 17
    s_add_u32 s66, s66, s64
    buffer_load_dwordx4 v[56:59], v1, s[36:39], s66 offen offset:0 nt
    buffer_load_dwordx4 v[60:63], v1, s[36:39], s66 offen offset:1024 nt
    buffer_load_dwordx4 v[64:67], v1, s[36:39], s66 offen offset:2048 nt
    buffer_load_dwordx4 v[68:71], v1, s[36:39], s66 offen offset:3072 nt
    s_mov_b32 s40, s8
    s_and_b32 s41, s9, 0xffff
    s_mov_b32 s42, 0x4000000
    s_mov_b32 s43, 0x20000
    v_and_b32 v10, 1, v0
    v_lshlrev_b32 v10, 4, v10
    v_mov_b32 v11, 0xffff
    v_lshlrev_b32 v10, v10, v11
    v_bfe_u32 v11, v0, 1, 2
    v_cmp_eq_u32 s[80:81], 0, v11
    v_cmp_eq_u32 s[82:83], 1, v11
    s_nop 0
    v_cndmask_b32 v4, 0, v10, s[80:81]
    v_cndmask_b32 v5, 0, v10, s[82:83]
    v_cmp_eq_u32 s[80:81], 2, v11
    v_cmp_eq_u32 s[82:83], 3, v11
    s_nop 0
    v_cndmask_b32 v6, 0, v10, s[80:81]
    v_cndmask_b32 v7, 0, v10, s[82:83]
    s_mov_b32 s76, 0x3db504f3
    s_mov_b32 s68, 0xf000f
    s_mov_b32 s69, 0xf000f
    s_mov_b32 s70, 0xf000f0
    s_mov_b32 s71, 0xf000f0
    s_mov_b32 s72, 0xf000f00
    s_mov_b32 s73, 0xf000f00
    s_mov_b32 s74, 0xf000f000
    s_mov_b32 s75, 0xf000f000
    v_lshrrev_b32 v9, 4, v0
    v_lshlrev_b32 v9, 2, v9
    v_and_b32 v8, 3, v0
    v_add_u32 v8, v8, v9
    v_lshlrev_b32 v8, 4, v8
    s_add_u32 s66, s65, 1
    s_and_b32 s66, s66, 15
    s_lshl_b32 s66, s66, 17
    s_add_u32 s66, s66, s64
    buffer_load_dwordx4 v[72:75], v1, s[36:39], s66 offen offset:0 nt
    buffer_load_dwordx4 v[76:79], v1, s[36:39], s66 offen offset:1024 nt
    buffer_load_dwordx4 v[80:83], v1, s[36:39], s66 offen offset:2048 nt
    s_waitcnt vmcnt(6)
    buffer_load_dwordx4 v[84:87], v1, s[36:39], s66 offen offset:3072 nt
    s_waitcnt vmcnt(6)
    s_add_u32 s66, s65, 2
    s_and_b32 s66, s66, 15
    s_lshl_b32 s66, s66, 17
    s_add_u32 s66, s66, s64
    buffer_load_dwordx4 v[88:91], v1, s[36:39], s66 offen offset:0 nt
    s_waitcnt vmcnt(6)
    buffer_load_dwordx4 v[92:95], v1, s[36:39], s66 offen offset:1024 nt
    s_waitcnt vmcnt(6)
    buffer_load_dwordx4 v[96:99], v1, s[36:39], s66 offen offset:2048 nt
    s_waitcnt vmcnt(6)
    buffer_load_dwordx4 v[100:103], v1, s[36:39], s66 offen offset:3072 nt
    s_waitcnt vmcnt(6)
    s_add_u32 s66, s65, 3
    s_and_b32 s66, s66, 15
    s_lshl_b32 s66, s66, 17
    s_add_u32 s66, s66, s64
    buffer_load_dwordx4 v[104:107], v1, s[36:39], s66 offen offset:0 nt
    s_waitcnt vmcnt(6)
    buffer_load_dwordx4 v[108:111], v1, s[36:39], s66 offen offset:1024 nt
    s_waitcnt vmcnt(6)
    buffer_load_dwordx4 v[112:115], v1, s[36:39], s66 offen offset:2048 nt
    s_waitcnt vmcnt(6)
    buffer_load_dwordx4 v[116:119], v1, s[36:39], s66 offen offset:3072 nt
    s_waitcnt vmcnt(6)
    s_add_u32 s66, s65, 4
    s_and_b32 s66, s66, 15
    s_lshl_b32 s66, s66, 17
    s_add_u32 s66, s66, s64
    buffer_load_dwordx4 v[120:123], v1, s[36:39], s66 offen offset:0 nt
    s_waitcnt vmcnt(6)
    buffer_load_dwordx4 v[124:127], v1, s[36:39], s66 offen offset:1024 nt
    s_waitcnt vmcnt(6)
    buffer_load_dwordx4 v[128:131], v1, s[36:39], s66 offen offset:2048 nt
    s_waitcnt vmcnt(6)
    buffer_load_dwordx4 v[132:135], v1, s[36:39], s66 offen offset:3072 nt
    s_waitcnt vmcnt(6)
    s_add_u32 s66, s65, 5
    s_and_b32 s66, s66, 15
    s_lshl_b32 s66, s66, 17
    s_add_u32 s66, s66, s64
    buffer_load_dwordx4 v[136:139], v1, s[36:39], s66 offen offset:0 nt
    s_waitcnt vmcnt(6)
    buffer_load_dwordx4 v[140:143], v1, s[36:39], s66 offen offset:1024 nt
    s_waitcnt vmcnt(6)
    buffer_load_dwordx4 v[144:147], v1, s[36:39], s66 offen offset:2048 nt
    s_waitcnt vmcnt(6)
    buffer_load_dwordx4 v[148:151], v1, s[36:39], s66 offen offset:3072 nt
    s_waitcnt vmcnt(6)
    s_add_u32 s66, s65, 6
    s_and_b32 s66, s66, 15
    s_lshl_b32 s66, s66, 17
    s_add_u32 s66, s66, s64
    buffer_load_dwordx4 v[152:155], v1, s[36:39], s66 offen offset:0 nt
    s_waitcnt vmcnt(6)
    buffer_load_dwordx4 v[156:159], v1, s[36:39], s66 offen offset:1024 nt
    s_waitcnt vmcnt(6)
    buffer_load_dwordx4 v[160:163], v1, s[36:39], s66 offen offset:2048 nt
    s_waitcnt vmcnt(6)
    buffer_load_dwordx4 v[164:167], v1, s[36:39], s66 offen offset:3072 nt
    s_waitcnt vmcnt(6)
    s_add_u32 s66, s65, 7
    s_and_b32 s66, s66, 15
    s_lshl_b32 s66, s66, 17
    s_add_u32 s66, s66, s64
    buffer_load_dwordx4 v[168:171], v1, s[36:39], s66 offen offset:0 nt
    s_waitcnt vmcnt(6)
    buffer_load_dwordx4 v[172:175], v1, s[36:39], s66 offen offset:1024 nt
    s_waitcnt vmcnt(6)
    buffer_load_dwordx4 v[176:179], v1, s[36:39], s66 offen offset:2048 nt
    s_waitcnt vmcnt(6)
    buffer_load_dwordx4 v[180:183], v1, s[36:39], s66 offen offset:3072 nt
    s_waitcnt vmcnt(6)
    s_add_u32 s66, s65, 8
    s_and_b32 s66, s66, 15
    s_lshl_b32 s66, s66, 17
    s_add_u32 s66, s66, s64
    buffer_load_dwordx4 v[184:187], v1, s[36:39], s66 offen offset:0 nt
    s_waitcnt vmcnt(6)
    buffer_load_dwordx4 v[188:191], v1, s[36:39], s66 offen offset:1024 nt
    s_waitcnt vmcnt(6)
    buffer_load_dwordx4 v[192:195], v1, s[36:39], s66 offen offset:2048 nt
    s_waitcnt vmcnt(6)
    buffer_load_dwordx4 v[196:199], v1, s[36:39], s66 offen offset:3072 nt
    s_waitcnt vmcnt(6)
    s_add_u32 s66, s65, 9
    s_and_b32 s66, s66, 15
    s_lshl_b32 s66, s66, 17
    s_add_u32 s66, s66, s64
    buffer_load_dwordx4 v[200:203], v1, s[36:39], s66 offen offset:0 nt
    s_waitcnt vmcnt(6)
    buffer_load_dwordx4 v[204:207], v1, s[36:39], s66 offen offset:1024 nt
    s_waitcnt vmcnt(6)
    buffer_load_dwordx4 v[208:211], v1, s[36:39], s66 offen offset:2048 nt
    s_waitcnt vmcnt(6)
    buffer_load_dwordx4 v[212:215], v1, s[36:39], s66 offen offset:3072 nt
    s_waitcnt lgkmcnt(0)
    s_barrier
    ds_read_b128 v[40:43], v8 offset:0
    s_waitcnt vmcnt(6)
    s_add_u32 s66, s65, 10
    s_and_b32 s66, s66, 15
    s_lshl_b32 s66, s66, 17
    s_add_u32 s66, s66, s64
    buffer_load_dwordx4 v[216:219], v1, s[36:39], s66 offen offset:0 nt
    s_waitcnt vmcnt(6)
    buffer_load_dwordx4 v[220:223], v1, s[36:39], s66 offen offset:1024 nt
    s_waitcnt vmcnt(6)
    buffer_load_dwordx4 v[224:227], v1, s[36:39], s66 offen offset:2048 nt
    s_waitcnt vmcnt(6)
    buffer_load_dwordx4 v[228:231], v1, s[36:39], s66 offen offset:3072 nt
    s_waitcnt lgkmcnt(0)
    v_cndmask_b32 v16, 0, v40, s[68:69]
    v_cndmask_b32 v17, 0, v41, s[68:69]
    v_cndmask_b32 v18, 0, v42, s[68:69]
    v_cndmask_b32 v19, 0, v43, s[68:69]
    v_cndmask_b32 v20, 0, v40, s[70:71]
    v_cndmask_b32 v21, 0, v41, s[70:71]
    v_cndmask_b32 v22, 0, v42, s[70:71]
    v_cndmask_b32 v23, 0, v43, s[70:71]
    v_cndmask_b32 v24, 0, v40, s[72:73]
    v_cndmask_b32 v25, 0, v41, s[72:73]
    v_cndmask_b32 v26, 0, v42, s[72:73]
    v_cndmask_b32 v27, 0, v43, s[72:73]
    v_cndmask_b32 v28, 0, v40, s[74:75]
    v_cndmask_b32 v29, 0, v41, s[74:75]
    v_cndmask_b32 v30, 0, v42, s[74:75]
    v_cndmask_b32 v31, 0, v43, s[74:75]
    v_mfma_f32_16x16x32_bf16 v[48:51], v[56:59], v[16:19], 0
    v_mfma_f32_16x16x32_bf16 v[48:51], v[60:63], v[20:23], v[48:51]
    v_mfma_f32_16x16x32_bf16 v[48:51], v[64:67], v[24:27], v[48:51]
    v_mfma_f32_16x16x32_bf16 v[48:51], v[68:71], v[28:31], v[48:51]
    v_mfma_f32_16x16x32_bf16 v[52:55], v[72:75], v[16:19], 0
    v_mfma_f32_16x16x32_bf16 v[52:55], v[76:79], v[20:23], v[52:55]
    v_mfma_f32_16x16x32_bf16 v[52:55], v[80:83], v[24:27], v[52:55]
    v_mfma_f32_16x16x32_bf16 v[52:55], v[84:87], v[28:31], v[52:55]
    s_nop 3
    v_mov_b32_dpp v32, v48 quad_perm:[0,0,0,0] row_mask:0xf bank_mask:0xf
    s_nop 1
    v_add_f32_dpp v32, v49, v32 quad_perm:[1,1,1,1] row_mask:0xf bank_mask:0xf
    s_nop 1
    v_add_f32_dpp v32, v50, v32 quad_perm:[2,2,2,2] row_mask:0xf bank_mask:0xf
    s_nop 1
    v_add_f32_dpp v32, v51, v32 quad_perm:[3,3,3,3] row_mask:0xf bank_mask:0xf
    v_mfma_f32_16x16x32_bf16 v[48:51], v[88:91], v[16:19], 0
    v_mfma_f32_16x16x32_bf16 v[48:51], v[92:95], v[20:23], v[48:51]
    v_mfma_f32_16x16x32_bf16 v[48:51], v[96:99], v[24:27], v[48:51]
    v_mfma_f32_16x16x32_bf16 v[48:51], v[100:103], v[28:31], v[48:51]
    v_mov_b32_dpp v33, v52 quad_perm:[0,0,0,0] row_mask:0xf bank_mask:0xf
    s_nop 1
    v_add_f32_dpp v33, v53, v33 quad_perm:[1,1,1,1] row_mask:0xf bank_mask:0xf
    s_nop 1
    v_add_f32_dpp v33, v54, v33 quad_perm:[2,2,2,2] row_mask:0xf bank_mask:0xf
    s_nop 1
    v_add_f32_dpp v33, v55, v33 quad_perm:[3,3,3,3] row_mask:0xf bank_mask:0xf
    v_cvt_pk_bf16_f32 v8, v32, v33
    v_lshlrev_b32 v9, 16, v8
    v_and_b32 v8, 0xffff0000, v8
    v_mul_f32 v9, s76, v9
    v_mul_f32 v8, s76, v8
    v_cvt_pk_bf16_f32 v8, v9, v8
    v_lshlrev_b32 v32, 16, v8
    v_and_b32 v33, 0xffff0000, v8
    s_waitcnt vmcnt(6)
    s_add_u32 s66, s65, 11
    s_and_b32 s66, s66, 15
    s_lshl_b32 s66, s66, 17
    s_add_u32 s66, s66, s64
    buffer_load_dwordx4 v[232:235], v1, s[36:39], s66 offen offset:0 nt
    s_waitcnt vmcnt(6)
    buffer_load_dwordx4 v[236:239], v1, s[36:39], s66 offen offset:1024 nt
    s_waitcnt vmcnt(6)
    buffer_load_dwordx4 v[240:243], v1, s[36:39], s66 offen offset:2048 nt
    s_waitcnt vmcnt(6)
    buffer_load_dwordx4 v[244:247], v1, s[36:39], s66 offen offset:3072 nt
    v_mfma_f32_16x16x32_bf16 v[52:55], v[104:107], v[16:19], 0
    v_mfma_f32_16x16x32_bf16 v[52:55], v[108:111], v[20:23], v[52:55]
    v_mfma_f32_16x16x32_bf16 v[52:55], v[112:115], v[24:27], v[52:55]
    v_mfma_f32_16x16x32_bf16 v[52:55], v[116:119], v[28:31], v[52:55]
    v_mov_b32_dpp v34, v48 quad_perm:[0,0,0,0] row_mask:0xf bank_mask:0xf
    s_nop 1
    v_add_f32_dpp v34, v49, v34 quad_perm:[1,1,1,1] row_mask:0xf bank_mask:0xf
    s_nop 1
    v_add_f32_dpp v34, v50, v34 quad_perm:[2,2,2,2] row_mask:0xf bank_mask:0xf
    s_nop 1
    v_add_f32_dpp v34, v51, v34 quad_perm:[3,3,3,3] row_mask:0xf bank_mask:0xf
    v_mfma_f32_16x16x32_bf16 v[48:51], v[120:123], v[16:19], 0
    v_mfma_f32_16x16x32_bf16 v[48:51], v[124:127], v[20:23], v[48:51]
    v_mfma_f32_16x16x32_bf16 v[48:51], v[128:131], v[24:27], v[48:51]
    v_mfma_f32_16x16x32_bf16 v[48:51], v[132:135], v[28:31], v[48:51]
    v_mov_b32_dpp v35, v52 quad_perm:[0,0,0,0] row_mask:0xf bank_mask:0xf
    s_nop 1
    v_add_f32_dpp v35, v53, v35 quad_perm:[1,1,1,1] row_mask:0xf bank_mask:0xf
    s_nop 1
    v_add_f32_dpp v35, v54, v35 quad_perm:[2,2,2,2] row_mask:0xf bank_mask:0xf
    s_nop 1
    v_add_f32_dpp v35, v55, v35 quad_perm:[3,3,3,3] row_mask:0xf bank_mask:0xf
    v_cvt_pk_bf16_f32 v8, v34, v35
    v_lshlrev_b32 v9, 16, v8
    v_and_b32 v8, 0xffff0000, v8
    v_mul_f32 v9, s76, v9
    v_mul_f32 v8, s76, v8
    v_cvt_pk_bf16_f32 v8, v9, v8
    v_lshlrev_b32 v34, 16, v8
    v_and_b32 v35, 0xffff0000, v8
    v_mfma_f32_16x16x32_bf16 v[52:55], v[136:139], v[16:19], 0
    v_mfma_f32_16x16x32_bf16 v[52:55], v[140:143], v[20:23], v[52:55]
    v_mfma_f32_16x16x32_bf16 v[52:55], v[144:147], v[24:27], v[52:55]
    v_mfma_f32_16x16x32_bf16 v[52:55], v[148:151], v[28:31], v[52:55]
    v_mov_b32_dpp v36, v48 quad_perm:[0,0,0,0] row_mask:0xf bank_mask:0xf
    s_nop 1
    v_add_f32_dpp v36, v49, v36 quad_perm:[1,1,1,1] row_mask:0xf bank_mask:0xf
    s_nop 1
    v_add_f32_dpp v36, v50, v36 quad_perm:[2,2,2,2] row_mask:0xf bank_mask:0xf
    s_nop 1
    v_add_f32_dpp v36, v51, v36 quad_perm:[3,3,3,3] row_mask:0xf bank_mask:0xf
    s_waitcnt vmcnt(6)
    s_add_u32 s66, s65, 12
    s_and_b32 s66, s66, 15
    s_lshl_b32 s66, s66, 17
    s_add_u32 s66, s66, s64
    buffer_load_dwordx4 v[248:251], v1, s[36:39], s66 offen offset:0 nt
    s_waitcnt vmcnt(6)
    buffer_load_dwordx4 v[252:255], v1, s[36:39], s66 offen offset:1024 nt
    s_waitcnt vmcnt(6)
    buffer_load_dwordx4 v[56:59], v1, s[36:39], s66 offen offset:2048 nt
    s_waitcnt vmcnt(6)
    buffer_load_dwordx4 v[60:63], v1, s[36:39], s66 offen offset:3072 nt
    v_mfma_f32_16x16x32_bf16 v[48:51], v[152:155], v[16:19], 0
    v_mfma_f32_16x16x32_bf16 v[48:51], v[156:159], v[20:23], v[48:51]
    v_mfma_f32_16x16x32_bf16 v[48:51], v[160:163], v[24:27], v[48:51]
    v_mfma_f32_16x16x32_bf16 v[48:51], v[164:167], v[28:31], v[48:51]
    v_mov_b32_dpp v37, v52 quad_perm:[0,0,0,0] row_mask:0xf bank_mask:0xf
    s_nop 1
    v_add_f32_dpp v37, v53, v37 quad_perm:[1,1,1,1] row_mask:0xf bank_mask:0xf
    s_nop 1
    v_add_f32_dpp v37, v54, v37 quad_perm:[2,2,2,2] row_mask:0xf bank_mask:0xf
    s_nop 1
    v_add_f32_dpp v37, v55, v37 quad_perm:[3,3,3,3] row_mask:0xf bank_mask:0xf
    v_cvt_pk_bf16_f32 v8, v36, v37
    v_lshlrev_b32 v9, 16, v8
    v_and_b32 v8, 0xffff0000, v8
    v_mul_f32 v9, s76, v9
    v_mul_f32 v8, s76, v8
    v_cvt_pk_bf16_f32 v8, v9, v8
    v_lshlrev_b32 v36, 16, v8
    v_and_b32 v37, 0xffff0000, v8
    v_mfma_f32_16x16x32_bf16 v[52:55], v[168:171], v[16:19], 0
    v_mfma_f32_16x16x32_bf16 v[52:55], v[172:175], v[20:23], v[52:55]
    v_mfma_f32_16x16x32_bf16 v[52:55], v[176:179], v[24:27], v[52:55]
    v_mfma_f32_16x16x32_bf16 v[52:55], v[180:183], v[28:31], v[52:55]
    v_mov_b32_dpp v38, v48 quad_perm:[0,0,0,0] row_mask:0xf bank_mask:0xf
    s_nop 1
    v_add_f32_dpp v38, v49, v38 quad_perm:[1,1,1,1] row_mask:0xf bank_mask:0xf
    s_nop 1
    v_add_f32_dpp v38, v50, v38 quad_perm:[2,2,2,2] row_mask:0xf bank_mask:0xf
    s_nop 1
    v_add_f32_dpp v38, v51, v38 quad_perm:[3,3,3,3] row_mask:0xf bank_mask:0xf
    v_mfma_f32_16x16x32_bf16 v[48:51], v[184:187], v[16:19], 0
    v_mfma_f32_16x16x32_bf16 v[48:51], v[188:191], v[20:23], v[48:51]
    v_mfma_f32_16x16x32_bf16 v[48:51], v[192:195], v[24:27], v[48:51]
    v_mfma_f32_16x16x32_bf16 v[48:51], v[196:199], v[28:31], v[48:51]
    v_mov_b32_dpp v39, v52 quad_perm:[0,0,0,0] row_mask:0xf bank_mask:0xf
    s_nop 1
    v_add_f32_dpp v39, v53, v39 quad_perm:[1,1,1,1] row_mask:0xf bank_mask:0xf
    s_nop 1
    v_add_f32_dpp v39, v54, v39 quad_perm:[2,2,2,2] row_mask:0xf bank_mask:0xf
    s_nop 1
    v_add_f32_dpp v39, v55, v39 quad_perm:[3,3,3,3] row_mask:0xf bank_mask:0xf
    v_cvt_pk_bf16_f32 v8, v38, v39
    v_lshlrev_b32 v9, 16, v8
    v_and_b32 v8, 0xffff0000, v8
    v_mul_f32 v9, s76, v9
    v_mul_f32 v8, s76, v8
    v_cvt_pk_bf16_f32 v8, v9, v8
    v_lshlrev_b32 v38, 16, v8
    v_and_b32 v39, 0xffff0000, v8
    s_waitcnt vmcnt(6)
    s_add_u32 s66, s65, 13
    s_and_b32 s66, s66, 15
    s_lshl_b32 s66, s66, 17
    s_add_u32 s66, s66, s64
    buffer_load_dwordx4 v[64:67], v1, s[36:39], s66 offen offset:0 nt
    s_waitcnt vmcnt(6)
    buffer_load_dwordx4 v[68:71], v1, s[36:39], s66 offen offset:1024 nt
    s_waitcnt vmcnt(6)
    buffer_load_dwordx4 v[72:75], v1, s[36:39], s66 offen offset:2048 nt
    s_waitcnt vmcnt(6)
    buffer_load_dwordx4 v[76:79], v1, s[36:39], s66 offen offset:3072 nt
    v_mfma_f32_16x16x32_bf16 v[52:55], v[200:203], v[16:19], 0
    v_mfma_f32_16x16x32_bf16 v[52:55], v[204:207], v[20:23], v[52:55]
    v_mfma_f32_16x16x32_bf16 v[52:55], v[208:211], v[24:27], v[52:55]
    v_mfma_f32_16x16x32_bf16 v[52:55], v[212:215], v[28:31], v[52:55]
    v_mov_b32_dpp v40, v48 quad_perm:[0,0,0,0] row_mask:0xf bank_mask:0xf
    s_nop 1
    v_add_f32_dpp v40, v49, v40 quad_perm:[1,1,1,1] row_mask:0xf bank_mask:0xf
    s_nop 1
    v_add_f32_dpp v40, v50, v40 quad_perm:[2,2,2,2] row_mask:0xf bank_mask:0xf
    s_nop 1
    v_add_f32_dpp v40, v51, v40 quad_perm:[3,3,3,3] row_mask:0xf bank_mask:0xf
    v_mfma_f32_16x16x32_bf16 v[48:51], v[216:219], v[16:19], 0
    v_mfma_f32_16x16x32_bf16 v[48:51], v[220:223], v[20:23], v[48:51]
    v_mfma_f32_16x16x32_bf16 v[48:51], v[224:227], v[24:27], v[48:51]
    v_mfma_f32_16x16x32_bf16 v[48:51], v[228:231], v[28:31], v[48:51]
    v_mov_b32_dpp v41, v52 quad_perm:[0,0,0,0] row_mask:0xf bank_mask:0xf
    s_nop 1
    v_add_f32_dpp v41, v53, v41 quad_perm:[1,1,1,1] row_mask:0xf bank_mask:0xf
    s_nop 1
    v_add_f32_dpp v41, v54, v41 quad_perm:[2,2,2,2] row_mask:0xf bank_mask:0xf
    s_nop 1
    v_add_f32_dpp v41, v55, v41 quad_perm:[3,3,3,3] row_mask:0xf bank_mask:0xf
    v_cvt_pk_bf16_f32 v8, v40, v41
    v_lshlrev_b32 v9, 16, v8
    v_and_b32 v8, 0xffff0000, v8
    v_mul_f32 v9, s76, v9
    v_mul_f32 v8, s76, v8
    v_cvt_pk_bf16_f32 v8, v9, v8
    v_lshlrev_b32 v40, 16, v8
    v_and_b32 v41, 0xffff0000, v8
    v_mfma_f32_16x16x32_bf16 v[52:55], v[232:235], v[16:19], 0
    v_mfma_f32_16x16x32_bf16 v[52:55], v[236:239], v[20:23], v[52:55]
    v_mfma_f32_16x16x32_bf16 v[52:55], v[240:243], v[24:27], v[52:55]
    v_mfma_f32_16x16x32_bf16 v[52:55], v[244:247], v[28:31], v[52:55]
    v_mov_b32_dpp v42, v48 quad_perm:[0,0,0,0] row_mask:0xf bank_mask:0xf
    s_nop 1
    v_add_f32_dpp v42, v49, v42 quad_perm:[1,1,1,1] row_mask:0xf bank_mask:0xf
    s_nop 1
    v_add_f32_dpp v42, v50, v42 quad_perm:[2,2,2,2] row_mask:0xf bank_mask:0xf
    s_nop 1
    v_add_f32_dpp v42, v51, v42 quad_perm:[3,3,3,3] row_mask:0xf bank_mask:0xf
    s_waitcnt vmcnt(6)
    s_add_u32 s66, s65, 14
    s_and_b32 s66, s66, 15
    s_lshl_b32 s66, s66, 17
    s_add_u32 s66, s66, s64
    buffer_load_dwordx4 v[80:83], v1, s[36:39], s66 offen offset:0 nt
    s_waitcnt vmcnt(6)
    buffer_load_dwordx4 v[84:87], v1, s[36:39], s66 offen offset:1024 nt
    s_waitcnt vmcnt(6)
    buffer_load_dwordx4 v[88:91], v1, s[36:39], s66 offen offset:2048 nt
    s_waitcnt vmcnt(6)
    buffer_load_dwordx4 v[92:95], v1, s[36:39], s66 offen offset:3072 nt
    v_mfma_f32_16x16x32_bf16 v[48:51], v[248:251], v[16:19], 0
    v_mfma_f32_16x16x32_bf16 v[48:51], v[252:255], v[20:23], v[48:51]
    v_mfma_f32_16x16x32_bf16 v[48:51], v[56:59], v[24:27], v[48:51]
    v_mfma_f32_16x16x32_bf16 v[48:51], v[60:63], v[28:31], v[48:51]
    v_mov_b32_dpp v43, v52 quad_perm:[0,0,0,0] row_mask:0xf bank_mask:0xf
    s_nop 1
    v_add_f32_dpp v43, v53, v43 quad_perm:[1,1,1,1] row_mask:0xf bank_mask:0xf
    s_nop 1
    v_add_f32_dpp v43, v54, v43 quad_perm:[2,2,2,2] row_mask:0xf bank_mask:0xf
    s_nop 1
    v_add_f32_dpp v43, v55, v43 quad_perm:[3,3,3,3] row_mask:0xf bank_mask:0xf
    v_cvt_pk_bf16_f32 v8, v42, v43
    v_lshlrev_b32 v9, 16, v8
    v_and_b32 v8, 0xffff0000, v8
    v_mul_f32 v9, s76, v9
    v_mul_f32 v8, s76, v8
    v_cvt_pk_bf16_f32 v8, v9, v8
    v_lshlrev_b32 v42, 16, v8
    v_and_b32 v43, 0xffff0000, v8
    s_waitcnt vmcnt(6)
    s_add_u32 s66, s65, 15
    s_and_b32 s66, s66, 15
    s_lshl_b32 s66, s66, 17
    s_add_u32 s66, s66, s64
    buffer_load_dwordx4 v[96:99], v1, s[36:39], s66 offen offset:0 nt
    s_waitcnt vmcnt(6)
    buffer_load_dwordx4 v[100:103], v1, s[36:39], s66 offen offset:1024 nt
    s_waitcnt vmcnt(6)
    buffer_load_dwordx4 v[104:107], v1, s[36:39], s66 offen offset:2048 nt
    s_waitcnt vmcnt(6)
    buffer_load_dwordx4 v[108:111], v1, s[36:39], s66 offen offset:3072 nt
    v_mfma_f32_16x16x32_bf16 v[52:55], v[64:67], v[16:19], 0
    v_mfma_f32_16x16x32_bf16 v[52:55], v[68:71], v[20:23], v[52:55]
    v_mfma_f32_16x16x32_bf16 v[52:55], v[72:75], v[24:27], v[52:55]
    v_mfma_f32_16x16x32_bf16 v[52:55], v[76:79], v[28:31], v[52:55]
    v_mov_b32_dpp v44, v48 quad_perm:[0,0,0,0] row_mask:0xf bank_mask:0xf
    s_nop 1
    v_add_f32_dpp v44, v49, v44 quad_perm:[1,1,1,1] row_mask:0xf bank_mask:0xf
    s_nop 1
    v_add_f32_dpp v44, v50, v44 quad_perm:[2,2,2,2] row_mask:0xf bank_mask:0xf
    s_nop 1
    v_add_f32_dpp v44, v51, v44 quad_perm:[3,3,3,3] row_mask:0xf bank_mask:0xf
    s_waitcnt vmcnt(6)
    s_add_u32 s66, s65, 0
    s_and_b32 s66, s66, 15
    s_lshl_b32 s66, s66, 17
    s_add_u32 s66, s66, s64
    buffer_load_dwordx4 v[112:115], v2, s[40:43], s66 offen offset:0 nt
    s_waitcnt vmcnt(6)
    buffer_load_dwordx4 v[116:119], v2, s[40:43], s66 offen offset:1024 nt
    s_waitcnt vmcnt(6)
    buffer_load_dwordx4 v[120:123], v2, s[40:43], s66 offen offset:2048 nt
    s_waitcnt vmcnt(6)
    buffer_load_dwordx4 v[124:127], v2, s[40:43], s66 offen offset:3072 nt
    v_mfma_f32_16x16x32_bf16 v[48:51], v[80:83], v[16:19], 0
    v_mfma_f32_16x16x32_bf16 v[48:51], v[84:87], v[20:23], v[48:51]
    v_mfma_f32_16x16x32_bf16 v[48:51], v[88:91], v[24:27], v[48:51]
    v_mfma_f32_16x16x32_bf16 v[48:51], v[92:95], v[28:31], v[48:51]
    v_mov_b32_dpp v45, v52 quad_perm:[0,0,0,0] row_mask:0xf bank_mask:0xf
    s_nop 1
    v_add_f32_dpp v45, v53, v45 quad_perm:[1,1,1,1] row_mask:0xf bank_mask:0xf
    s_nop 1
    v_add_f32_dpp v45, v54, v45 quad_perm:[2,2,2,2] row_mask:0xf bank_mask:0xf
    s_nop 1
    v_add_f32_dpp v45, v55, v45 quad_perm:[3,3,3,3] row_mask:0xf bank_mask:0xf
    v_cvt_pk_bf16_f32 v8, v44, v45
    v_lshlrev_b32 v9, 16, v8
    v_and_b32 v8, 0xffff0000, v8
    v_mul_f32 v9, s76, v9
    v_mul_f32 v8, s76, v8
    v_cvt_pk_bf16_f32 v8, v9, v8
    v_lshlrev_b32 v44, 16, v8
    v_and_b32 v45, 0xffff0000, v8
    s_waitcnt vmcnt(6)
    s_add_u32 s66, s65, 1
    s_and_b32 s66, s66, 15
    s_lshl_b32 s66, s66, 17
    s_add_u32 s66, s66, s64
    buffer_load_dwordx4 v[128:131], v2, s[40:43], s66 offen offset:0 nt
    s_waitcnt vmcnt(6)
    buffer_load_dwordx4 v[132:135], v2, s[40:43], s66 offen offset:1024 nt
    s_waitcnt vmcnt(6)
    buffer_load_dwordx4 v[136:139], v2, s[40:43], s66 offen offset:2048 nt
    s_waitcnt vmcnt(6)
    buffer_load_dwordx4 v[140:143], v2, s[40:43], s66 offen offset:3072 nt
    v_mfma_f32_16x16x32_bf16 v[52:55], v[96:99], v[16:19], 0
    v_mfma_f32_16x16x32_bf16 v[52:55], v[100:103], v[20:23], v[52:55]
    v_mfma_f32_16x16x32_bf16 v[52:55], v[104:107], v[24:27], v[52:55]
    v_mfma_f32_16x16x32_bf16 v[52:55], v[108:111], v[28:31], v[52:55]
    v_mov_b32_dpp v46, v48 quad_perm:[0,0,0,0] row_mask:0xf bank_mask:0xf
    s_nop 1
    v_add_f32_dpp v46, v49, v46 quad_perm:[1,1,1,1] row_mask:0xf bank_mask:0xf
    s_nop 1
    v_add_f32_dpp v46, v50, v46 quad_perm:[2,2,2,2] row_mask:0xf bank_mask:0xf
    s_nop 1
    v_add_f32_dpp v46, v51, v46 quad_perm:[3,3,3,3] row_mask:0xf bank_mask:0xf
    s_waitcnt vmcnt(6)
    s_add_u32 s66, s65, 2
    s_and_b32 s66, s66, 15
    s_lshl_b32 s66, s66, 17
    s_add_u32 s66, s66, s64
    buffer_load_dwordx4 v[144:147], v2, s[40:43], s66 offen offset:0 nt
    s_waitcnt vmcnt(6)
    buffer_load_dwordx4 v[148:151], v2, s[40:43], s66 offen offset:1024 nt
    s_waitcnt vmcnt(6)
    buffer_load_dwordx4 v[152:155], v2, s[40:43], s66 offen offset:2048 nt
    s_waitcnt vmcnt(6)
    buffer_load_dwordx4 v[156:159], v2, s[40:43], s66 offen offset:3072 nt
    v_mov_b32_dpp v47, v52 quad_perm:[0,0,0,0] row_mask:0xf bank_mask:0xf
    s_nop 1
    v_add_f32_dpp v47, v53, v47 quad_perm:[1,1,1,1] row_mask:0xf bank_mask:0xf
    s_nop 1
    v_add_f32_dpp v47, v54, v47 quad_perm:[2,2,2,2] row_mask:0xf bank_mask:0xf
    s_nop 1
    v_add_f32_dpp v47, v55, v47 quad_perm:[3,3,3,3] row_mask:0xf bank_mask:0xf
    v_cvt_pk_bf16_f32 v8, v46, v47
    v_lshlrev_b32 v9, 16, v8
    v_and_b32 v8, 0xffff0000, v8
    v_mul_f32 v9, s76, v9
    v_mul_f32 v8, s76, v8
    v_cvt_pk_bf16_f32 v8, v9, v8
    v_lshlrev_b32 v46, 16, v8
    v_and_b32 v47, 0xffff0000, v8
    v_max3_f32 v12, v32, v33, v34
    v_max3_f32 v12, v12, v35, v36
    v_max3_f32 v12, v12, v37, v38
    v_max3_f32 v12, v12, v39, v40
    v_max3_f32 v12, v12, v41, v42
    v_max3_f32 v12, v12, v43, v44
    v_max3_f32 v12, v12, v45, v46
    v_max_f32 v12, v12, v47
    s_nop 1
    v_max_f32_dpp v12, v12, v12 row_ror:4 row_mask:0xf bank_mask:0xf
    s_nop 1
    v_max_f32_dpp v12, v12, v12 row_ror:8 row_mask:0xf bank_mask:0xf
    v_mov_b32 v8, v12
    s_nop 1
    v_permlane16_swap_b32 v8, v12
    v_max_f32 v12, v12, v8
    v_mov_b32 v8, v12
    s_nop 1
    v_permlane32_swap_b32 v8, v12
    v_max_f32 v12, v12, v8
    v_sub_f32 v32, v32, v12
    v_sub_f32 v33, v33, v12
    v_sub_f32 v34, v34, v12
    v_sub_f32 v35, v35, v12
    v_sub_f32 v36, v36, v12
    v_sub_f32 v37, v37, v12
    v_sub_f32 v38, v38, v12
    v_sub_f32 v39, v39, v12
    v_sub_f32 v40, v40, v12
    v_sub_f32 v41, v41, v12
    v_sub_f32 v42, v42, v12
    v_sub_f32 v43, v43, v12
    v_sub_f32 v44, v44, v12
    v_sub_f32 v45, v45, v12
    v_sub_f32 v46, v46, v12
    v_sub_f32 v47, v47, v12
    v_mul_f32 v32, s77, v32
    v_mul_f32 v33, s77, v33
    v_mul_f32 v34, s77, v34
    v_mul_f32 v35, s77, v35
    v_mul_f32 v36, s77, v36
    v_mul_f32 v37, s77, v37
    v_mul_f32 v38, s77, v38
    v_mul_f32 v39, s77, v39
    v_mul_f32 v40, s77, v40
    v_mul_f32 v41, s77, v41
    v_mul_f32 v42, s77, v42
    v_mul_f32 v43, s77, v43
    v_mul_f32 v44, s77, v44
    v_mul_f32 v45, s77, v45
    v_mul_f32 v46, s77, v46
    v_mul_f32 v47, s77, v47
    v_exp_f32 v32, v32
    v_exp_f32 v33, v33
    v_exp_f32 v34, v34
    v_exp_f32 v35, v35
    v_exp_f32 v36, v36
    v_exp_f32 v37, v37
    v_exp_f32 v38, v38
    v_exp_f32 v39, v39
    v_exp_f32 v40, v40
    v_exp_f32 v41, v41
    v_exp_f32 v42, v42
    v_exp_f32 v43, v43
    v_exp_f32 v44, v44
    v_exp_f32 v45, v45
    v_exp_f32 v46, v46
    v_exp_f32 v47, v47
    v_add_f32 v13, v32, v33
    v_add_f32 v8, v34, v35
    v_add_f32 v13, v13, v36
    v_add_f32 v8, v8, v37
    v_add_f32 v13, v13, v38
    v_add_f32 v8, v8, v39
    v_add_f32 v13, v13, v40
    v_add_f32 v8, v8, v41
    v_add_f32 v13, v13, v42
    v_add_f32 v8, v8, v43
    v_add_f32 v13, v13, v44
    v_add_f32 v8, v8, v45
    v_add_f32 v13, v13, v46
    v_add_f32 v8, v8, v47
    v_add_f32 v13, v13, v8
    v_cvt_pk_bf16_f32 v32, v32, v32
    v_cvt_pk_bf16_f32 v33, v33, v33
    v_cvt_pk_bf16_f32 v34, v34, v34
    v_cvt_pk_bf16_f32 v35, v35, v35
    v_cvt_pk_bf16_f32 v36, v36, v36
    v_cvt_pk_bf16_f32 v37, v37, v37
    v_cvt_pk_bf16_f32 v38, v38, v38
    v_cvt_pk_bf16_f32 v39, v39, v39
    v_cvt_pk_bf16_f32 v40, v40, v40
    v_cvt_pk_bf16_f32 v41, v41, v41
    v_cvt_pk_bf16_f32 v42, v42, v42
    v_cvt_pk_bf16_f32 v43, v43, v43
    v_cvt_pk_bf16_f32 v44, v44, v44
    v_cvt_pk_bf16_f32 v45, v45, v45
    v_cvt_pk_bf16_f32 v46, v46, v46
    v_cvt_pk_bf16_f32 v47, v47, v47
    v_add_f32_dpp v13, v13, v13 row_ror:4 row_mask:0xf bank_mask:0xf
    s_nop 1
    v_add_f32_dpp v13, v13, v13 row_ror:8 row_mask:0xf bank_mask:0xf
    v_mov_b32 v8, v13
    s_nop 1
    v_permlane16_swap_b32 v8, v13
    v_add_f32 v13, v13, v8
    v_mov_b32 v8, v13
    s_nop 1
    v_permlane32_swap_b32 v8, v13
    v_add_f32 v13, v13, v8
    s_lshl_b32 s79, s28, 3
    v_mov_b32 v9, s79
    ds_write_b64 v9, v[12:13] offset:2560
    v_and_b32_dpp v16, v32, v4 row_newbcast:0 row_mask:0xf bank_mask:0xf
    v_and_b32_dpp v17, v32, v5 row_newbcast:0 row_mask:0xf bank_mask:0xf
    v_and_b32_dpp v18, v32, v6 row_newbcast:0 row_mask:0xf bank_mask:0xf
    v_and_b32_dpp v19, v32, v7 row_newbcast:0 row_mask:0xf bank_mask:0xf
    v_and_b32_dpp v20, v32, v4 row_newbcast:4 row_mask:0xf bank_mask:0xf
    v_and_b32_dpp v21, v32, v5 row_newbcast:4 row_mask:0xf bank_mask:0xf
    v_and_b32_dpp v22, v32, v6 row_newbcast:4 row_mask:0xf bank_mask:0xf
    v_and_b32_dpp v23, v32, v7 row_newbcast:4 row_mask:0xf bank_mask:0xf
    v_and_b32_dpp v24, v32, v4 row_newbcast:8 row_mask:0xf bank_mask:0xf
    v_and_b32_dpp v25, v32, v5 row_newbcast:8 row_mask:0xf bank_mask:0xf
    v_and_b32_dpp v26, v32, v6 row_newbcast:8 row_mask:0xf bank_mask:0xf
    v_and_b32_dpp v27, v32, v7 row_newbcast:8 row_mask:0xf bank_mask:0xf
    v_and_b32_dpp v28, v32, v4 row_newbcast:12 row_mask:0xf bank_mask:0xf
    v_and_b32_dpp v29, v32, v5 row_newbcast:12 row_mask:0xf bank_mask:0xf
    v_and_b32_dpp v30, v32, v6 row_newbcast:12 row_mask:0xf bank_mask:0xf
    v_and_b32_dpp v31, v32, v7 row_newbcast:12 row_mask:0xf bank_mask:0xf
    v_mfma_f32_16x16x32_bf16 v[48:51], v[16:19], v[112:115], 0
    v_mfma_f32_16x16x32_bf16 v[48:51], v[20:23], v[116:119], v[48:51]
    v_mfma_f32_16x16x32_bf16 v[48:51], v[24:27], v[120:123], v[48:51]
    v_mfma_f32_16x16x32_bf16 v[48:51], v[28:31], v[124:127], v[48:51]
    s_waitcnt vmcnt(6)
    s_add_u32 s66, s65, 3
    s_and_b32 s66, s66, 15
    s_lshl_b32 s66, s66, 17
    s_add_u32 s66, s66, s64
    buffer_load_dwordx4 v[160:163], v2, s[40:43], s66 offen offset:0 nt
    s_waitcnt vmcnt(6)
    buffer_load_dwordx4 v[164:167], v2, s[40:43], s66 offen offset:1024 nt
    s_waitcnt vmcnt(6)
    buffer_load_dwordx4 v[168:171], v2, s[40:43], s66 offen offset:2048 nt
    s_waitcnt vmcnt(6)
    buffer_load_dwordx4 v[172:175], v2, s[40:43], s66 offen offset:3072 nt
    v_and_b32_dpp v16, v33, v4 row_newbcast:0 row_mask:0xf bank_mask:0xf
    v_and_b32_dpp v17, v33, v5 row_newbcast:0 row_mask:0xf bank_mask:0xf
    v_and_b32_dpp v18, v33, v6 row_newbcast:0 row_mask:0xf bank_mask:0xf
    v_and_b32_dpp v19, v33, v7 row_newbcast:0 row_mask:0xf bank_mask:0xf
    v_and_b32_dpp v20, v33, v4 row_newbcast:4 row_mask:0xf bank_mask:0xf
    v_and_b32_dpp v21, v33, v5 row_newbcast:4 row_mask:0xf bank_mask:0xf
    v_and_b32_dpp v22, v33, v6 row_newbcast:4 row_mask:0xf bank_mask:0xf
    v_and_b32_dpp v23, v33, v7 row_newbcast:4 row_mask:0xf bank_mask:0xf
    v_and_b32_dpp v24, v33, v4 row_newbcast:8 row_mask:0xf bank_mask:0xf
    v_and_b32_dpp v25, v33, v5 row_newbcast:8 row_mask:0xf bank_mask:0xf
    v_and_b32_dpp v26, v33, v6 row_newbcast:8 row_mask:0xf bank_mask:0xf
    v_and_b32_dpp v27, v33, v7 row_newbcast:8 row_mask:0xf bank_mask:0xf
    v_and_b32_dpp v28, v33, v4 row_newbcast:12 row_mask:0xf bank_mask:0xf
    v_and_b32_dpp v29, v33, v5 row_newbcast:12 row_mask:0xf bank_mask:0xf
    v_and_b32_dpp v30, v33, v6 row_newbcast:12 row_mask:0xf bank_mask:0xf
    v_and_b32_dpp v31, v33, v7 row_newbcast:12 row_mask:0xf bank_mask:0xf
    v_mfma_f32_16x16x32_bf16 v[48:51], v[16:19], v[128:131], v[48:51]
    v_mfma_f32_16x16x32_bf16 v[48:51], v[20:23], v[132:135], v[48:51]
    v_mfma_f32_16x16x32_bf16 v[48:51], v[24:27], v[136:139], v[48:51]
    v_mfma_f32_16x16x32_bf16 v[48:51], v[28:31], v[140:143], v[48:51]
    s_waitcnt vmcnt(6)
    s_add_u32 s66, s65, 4
    s_and_b32 s66, s66, 15
    s_lshl_b32 s66, s66, 17
    s_add_u32 s66, s66, s64
    buffer_load_dwordx4 v[176:179], v2, s[40:43], s66 offen offset:0 nt
    s_waitcnt vmcnt(6)
    buffer_load_dwordx4 v[180:183], v2, s[40:43], s66 offen offset:1024 nt
    s_waitcnt vmcnt(6)
    buffer_load_dwordx4 v[184:187], v2, s[40:43], s66 offen offset:2048 nt
    s_waitcnt vmcnt(6)
    buffer_load_dwordx4 v[188:191], v2, s[40:43], s66 offen offset:3072 nt
    v_and_b32_dpp v16, v34, v4 row_newbcast:0 row_mask:0xf bank_mask:0xf
    v_and_b32_dpp v17, v34, v5 row_newbcast:0 row_mask:0xf bank_mask:0xf
    v_and_b32_dpp v18, v34, v6 row_newbcast:0 row_mask:0xf bank_mask:0xf
    v_and_b32_dpp v19, v34, v7 row_newbcast:0 row_mask:0xf bank_mask:0xf
    v_and_b32_dpp v20, v34, v4 row_newbcast:4 row_mask:0xf bank_mask:0xf
    v_and_b32_dpp v21, v34, v5 row_newbcast:4 row_mask:0xf bank_mask:0xf
    v_and_b32_dpp v22, v34, v6 row_newbcast:4 row_mask:0xf bank_mask:0xf
    v_and_b32_dpp v23, v34, v7 row_newbcast:4 row_mask:0xf bank_mask:0xf
    v_and_b32_dpp v24, v34, v4 row_newbcast:8 row_mask:0xf bank_mask:0xf
    v_and_b32_dpp v25, v34, v5 row_newbcast:8 row_mask:0xf bank_mask:0xf
    v_and_b32_dpp v26, v34, v6 row_newbcast:8 row_mask:0xf bank_mask:0xf
    v_and_b32_dpp v27, v34, v7 row_newbcast:8 row_mask:0xf bank_mask:0xf
    v_and_b32_dpp v28, v34, v4 row_newbcast:12 row_mask:0xf bank_mask:0xf
    v_and_b32_dpp v29, v34, v5 row_newbcast:12 row_mask:0xf bank_mask:0xf
    v_and_b32_dpp v30, v34, v6 row_newbcast:12 row_mask:0xf bank_mask:0xf
    v_and_b32_dpp v31, v34, v7 row_newbcast:12 row_mask:0xf bank_mask:0xf
    v_mfma_f32_16x16x32_bf16 v[48:51], v[16:19], v[144:147], v[48:51]
    v_mfma_f32_16x16x32_bf16 v[48:51], v[20:23], v[148:151], v[48:51]
    v_mfma_f32_16x16x32_bf16 v[48:51], v[24:27], v[152:155], v[48:51]
    v_mfma_f32_16x16x32_bf16 v[48:51], v[28:31], v[156:159], v[48:51]
    s_waitcnt vmcnt(6)
    s_add_u32 s66, s65, 5
    s_and_b32 s66, s66, 15
    s_lshl_b32 s66, s66, 17
    s_add_u32 s66, s66, s64
    buffer_load_dwordx4 v[192:195], v2, s[40:43], s66 offen offset:0 nt
    s_waitcnt vmcnt(6)
    buffer_load_dwordx4 v[196:199], v2, s[40:43], s66 offen offset:1024 nt
    s_waitcnt vmcnt(6)
    buffer_load_dwordx4 v[200:203], v2, s[40:43], s66 offen offset:2048 nt
    s_waitcnt vmcnt(6)
    buffer_load_dwordx4 v[204:207], v2, s[40:43], s66 offen offset:3072 nt
    v_and_b32_dpp v16, v35, v4 row_newbcast:0 row_mask:0xf bank_mask:0xf
    v_and_b32_dpp v17, v35, v5 row_newbcast:0 row_mask:0xf bank_mask:0xf
    v_and_b32_dpp v18, v35, v6 row_newbcast:0 row_mask:0xf bank_mask:0xf
    v_and_b32_dpp v19, v35, v7 row_newbcast:0 row_mask:0xf bank_mask:0xf
    v_and_b32_dpp v20, v35, v4 row_newbcast:4 row_mask:0xf bank_mask:0xf
    v_and_b32_dpp v21, v35, v5 row_newbcast:4 row_mask:0xf bank_mask:0xf
    v_and_b32_dpp v22, v35, v6 row_newbcast:4 row_mask:0xf bank_mask:0xf
    v_and_b32_dpp v23, v35, v7 row_newbcast:4 row_mask:0xf bank_mask:0xf
    v_and_b32_dpp v24, v35, v4 row_newbcast:8 row_mask:0xf bank_mask:0xf
    v_and_b32_dpp v25, v35, v5 row_newbcast:8 row_mask:0xf bank_mask:0xf
    v_and_b32_dpp v26, v35, v6 row_newbcast:8 row_mask:0xf bank_mask:0xf
    v_and_b32_dpp v27, v35, v7 row_newbcast:8 row_mask:0xf bank_mask:0xf
    v_and_b32_dpp v28, v35, v4 row_newbcast:12 row_mask:0xf bank_mask:0xf
    v_and_b32_dpp v29, v35, v5 row_newbcast:12 row_mask:0xf bank_mask:0xf
    v_and_b32_dpp v30, v35, v6 row_newbcast:12 row_mask:0xf bank_mask:0xf
    v_and_b32_dpp v31, v35, v7 row_newbcast:12 row_mask:0xf bank_mask:0xf
    v_mfma_f32_16x16x32_bf16 v[48:51], v[16:19], v[160:163], v[48:51]
    v_mfma_f32_16x16x32_bf16 v[48:51], v[20:23], v[164:167], v[48:51]
    v_mfma_f32_16x16x32_bf16 v[48:51], v[24:27], v[168:171], v[48:51]
    v_mfma_f32_16x16x32_bf16 v[48:51], v[28:31], v[172:175], v[48:51]
    s_waitcnt vmcnt(6)
    s_add_u32 s66, s65, 6
    s_and_b32 s66, s66, 15
    s_lshl_b32 s66, s66, 17
    s_add_u32 s66, s66, s64
    buffer_load_dwordx4 v[208:211], v2, s[40:43], s66 offen offset:0 nt
    s_waitcnt vmcnt(6)
    buffer_load_dwordx4 v[212:215], v2, s[40:43], s66 offen offset:1024 nt
    s_waitcnt vmcnt(6)
    buffer_load_dwordx4 v[216:219], v2, s[40:43], s66 offen offset:2048 nt
    s_waitcnt vmcnt(6)
    buffer_load_dwordx4 v[220:223], v2, s[40:43], s66 offen offset:3072 nt
    v_and_b32_dpp v16, v36, v4 row_newbcast:0 row_mask:0xf bank_mask:0xf
    v_and_b32_dpp v17, v36, v5 row_newbcast:0 row_mask:0xf bank_mask:0xf
    v_and_b32_dpp v18, v36, v6 row_newbcast:0 row_mask:0xf bank_mask:0xf
    v_and_b32_dpp v19, v36, v7 row_newbcast:0 row_mask:0xf bank_mask:0xf
    v_and_b32_dpp v20, v36, v4 row_newbcast:4 row_mask:0xf bank_mask:0xf
    v_and_b32_dpp v21, v36, v5 row_newbcast:4 row_mask:0xf bank_mask:0xf
    v_and_b32_dpp v22, v36, v6 row_newbcast:4 row_mask:0xf bank_mask:0xf
    v_and_b32_dpp v23, v36, v7 row_newbcast:4 row_mask:0xf bank_mask:0xf
    v_and_b32_dpp v24, v36, v4 row_newbcast:8 row_mask:0xf bank_mask:0xf
    v_and_b32_dpp v25, v36, v5 row_newbcast:8 row_mask:0xf bank_mask:0xf
    v_and_b32_dpp v26, v36, v6 row_newbcast:8 row_mask:0xf bank_mask:0xf
    v_and_b32_dpp v27, v36, v7 row_newbcast:8 row_mask:0xf bank_mask:0xf
    v_and_b32_dpp v28, v36, v4 row_newbcast:12 row_mask:0xf bank_mask:0xf
    v_and_b32_dpp v29, v36, v5 row_newbcast:12 row_mask:0xf bank_mask:0xf
    v_and_b32_dpp v30, v36, v6 row_newbcast:12 row_mask:0xf bank_mask:0xf
    v_and_b32_dpp v31, v36, v7 row_newbcast:12 row_mask:0xf bank_mask:0xf
    v_mfma_f32_16x16x32_bf16 v[48:51], v[16:19], v[176:179], v[48:51]
    v_mfma_f32_16x16x32_bf16 v[48:51], v[20:23], v[180:183], v[48:51]
    v_mfma_f32_16x16x32_bf16 v[48:51], v[24:27], v[184:187], v[48:51]
    v_mfma_f32_16x16x32_bf16 v[48:51], v[28:31], v[188:191], v[48:51]
    s_waitcnt vmcnt(6)
    s_add_u32 s66, s65, 7
    s_and_b32 s66, s66, 15
    s_lshl_b32 s66, s66, 17
    s_add_u32 s66, s66, s64
    buffer_load_dwordx4 v[224:227], v2, s[40:43], s66 offen offset:0 nt
    s_waitcnt vmcnt(6)
    buffer_load_dwordx4 v[228:231], v2, s[40:43], s66 offen offset:1024 nt
    s_waitcnt vmcnt(6)
    buffer_load_dwordx4 v[232:235], v2, s[40:43], s66 offen offset:2048 nt
    s_waitcnt vmcnt(6)
    buffer_load_dwordx4 v[236:239], v2, s[40:43], s66 offen offset:3072 nt
    v_and_b32_dpp v16, v37, v4 row_newbcast:0 row_mask:0xf bank_mask:0xf
    v_and_b32_dpp v17, v37, v5 row_newbcast:0 row_mask:0xf bank_mask:0xf
    v_and_b32_dpp v18, v37, v6 row_newbcast:0 row_mask:0xf bank_mask:0xf
    v_and_b32_dpp v19, v37, v7 row_newbcast:0 row_mask:0xf bank_mask:0xf
    v_and_b32_dpp v20, v37, v4 row_newbcast:4 row_mask:0xf bank_mask:0xf
    v_and_b32_dpp v21, v37, v5 row_newbcast:4 row_mask:0xf bank_mask:0xf
    v_and_b32_dpp v22, v37, v6 row_newbcast:4 row_mask:0xf bank_mask:0xf
    v_and_b32_dpp v23, v37, v7 row_newbcast:4 row_mask:0xf bank_mask:0xf
    v_and_b32_dpp v24, v37, v4 row_newbcast:8 row_mask:0xf bank_mask:0xf
    v_and_b32_dpp v25, v37, v5 row_newbcast:8 row_mask:0xf bank_mask:0xf
    v_and_b32_dpp v26, v37, v6 row_newbcast:8 row_mask:0xf bank_mask:0xf
    v_and_b32_dpp v27, v37, v7 row_newbcast:8 row_mask:0xf bank_mask:0xf
    v_and_b32_dpp v28, v37, v4 row_newbcast:12 row_mask:0xf bank_mask:0xf
    v_and_b32_dpp v29, v37, v5 row_newbcast:12 row_mask:0xf bank_mask:0xf
    v_and_b32_dpp v30, v37, v6 row_newbcast:12 row_mask:0xf bank_mask:0xf
    v_and_b32_dpp v31, v37, v7 row_newbcast:12 row_mask:0xf bank_mask:0xf
    v_mfma_f32_16x16x32_bf16 v[48:51], v[16:19], v[192:195], v[48:51]
    v_mfma_f32_16x16x32_bf16 v[48:51], v[20:23], v[196:199], v[48:51]
    v_mfma_f32_16x16x32_bf16 v[48:51], v[24:27], v[200:203], v[48:51]
    v_mfma_f32_16x16x32_bf16 v[48:51], v[28:31], v[204:207], v[48:51]
    s_waitcnt vmcnt(6)
    s_add_u32 s66, s65, 8
    s_and_b32 s66, s66, 15
    s_lshl_b32 s66, s66, 17
    s_add_u32 s66, s66, s64
    buffer_load_dwordx4 v[240:243], v2, s[40:43], s66 offen offset:0 nt
    s_waitcnt vmcnt(6)
    buffer_load_dwordx4 v[244:247], v2, s[40:43], s66 offen offset:1024 nt
    s_waitcnt vmcnt(6)
    buffer_load_dwordx4 v[248:251], v2, s[40:43], s66 offen offset:2048 nt
    s_waitcnt vmcnt(6)
    buffer_load_dwordx4 v[252:255], v2, s[40:43], s66 offen offset:3072 nt
    v_and_b32_dpp v16, v38, v4 row_newbcast:0 row_mask:0xf bank_mask:0xf
    v_and_b32_dpp v17, v38, v5 row_newbcast:0 row_mask:0xf bank_mask:0xf
    v_and_b32_dpp v18, v38, v6 row_newbcast:0 row_mask:0xf bank_mask:0xf
    v_and_b32_dpp v19, v38, v7 row_newbcast:0 row_mask:0xf bank_mask:0xf
    v_and_b32_dpp v20, v38, v4 row_newbcast:4 row_mask:0xf bank_mask:0xf
    v_and_b32_dpp v21, v38, v5 row_newbcast:4 row_mask:0xf bank_mask:0xf
    v_and_b32_dpp v22, v38, v6 row_newbcast:4 row_mask:0xf bank_mask:0xf
    v_and_b32_dpp v23, v38, v7 row_newbcast:4 row_mask:0xf bank_mask:0xf
    v_and_b32_dpp v24, v38, v4 row_newbcast:8 row_mask:0xf bank_mask:0xf
    v_and_b32_dpp v25, v38, v5 row_newbcast:8 row_mask:0xf bank_mask:0xf
    v_and_b32_dpp v26, v38, v6 row_newbcast:8 row_mask:0xf bank_mask:0xf
    v_and_b32_dpp v27, v38, v7 row_newbcast:8 row_mask:0xf bank_mask:0xf
    v_and_b32_dpp v28, v38, v4 row_newbcast:12 row_mask:0xf bank_mask:0xf
    v_and_b32_dpp v29, v38, v5 row_newbcast:12 row_mask:0xf bank_mask:0xf
    v_and_b32_dpp v30, v38, v6 row_newbcast:12 row_mask:0xf bank_mask:0xf
    v_and_b32_dpp v31, v38, v7 row_newbcast:12 row_mask:0xf bank_mask:0xf
    v_mfma_f32_16x16x32_bf16 v[48:51], v[16:19], v[208:211], v[48:51]
    v_mfma_f32_16x16x32_bf16 v[48:51], v[20:23], v[212:215], v[48:51]
    v_mfma_f32_16x16x32_bf16 v[48:51], v[24:27], v[216:219], v[48:51]
    v_mfma_f32_16x16x32_bf16 v[48:51], v[28:31], v[220:223], v[48:51]
    s_waitcnt vmcnt(6)
    s_add_u32 s66, s65, 9
    s_and_b32 s66, s66, 15
    s_lshl_b32 s66, s66, 17
    s_add_u32 s66, s66, s64
    buffer_load_dwordx4 v[56:59], v2, s[40:43], s66 offen offset:0 nt
    s_waitcnt vmcnt(6)
    buffer_load_dwordx4 v[60:63], v2, s[40:43], s66 offen offset:1024 nt
    s_waitcnt vmcnt(6)
    buffer_load_dwordx4 v[64:67], v2, s[40:43], s66 offen offset:2048 nt
    s_waitcnt vmcnt(6)
    buffer_load_dwordx4 v[68:71], v2, s[40:43], s66 offen offset:3072 nt
    v_and_b32_dpp v16, v39, v4 row_newbcast:0 row_mask:0xf bank_mask:0xf
    v_and_b32_dpp v17, v39, v5 row_newbcast:0 row_mask:0xf bank_mask:0xf
    v_and_b32_dpp v18, v39, v6 row_newbcast:0 row_mask:0xf bank_mask:0xf
    v_and_b32_dpp v19, v39, v7 row_newbcast:0 row_mask:0xf bank_mask:0xf
    v_and_b32_dpp v20, v39, v4 row_newbcast:4 row_mask:0xf bank_mask:0xf
    v_and_b32_dpp v21, v39, v5 row_newbcast:4 row_mask:0xf bank_mask:0xf
    v_and_b32_dpp v22, v39, v6 row_newbcast:4 row_mask:0xf bank_mask:0xf
    v_and_b32_dpp v23, v39, v7 row_newbcast:4 row_mask:0xf bank_mask:0xf
    v_and_b32_dpp v24, v39, v4 row_newbcast:8 row_mask:0xf bank_mask:0xf
    v_and_b32_dpp v25, v39, v5 row_newbcast:8 row_mask:0xf bank_mask:0xf
    v_and_b32_dpp v26, v39, v6 row_newbcast:8 row_mask:0xf bank_mask:0xf
    v_and_b32_dpp v27, v39, v7 row_newbcast:8 row_mask:0xf bank_mask:0xf
    v_and_b32_dpp v28, v39, v4 row_newbcast:12 row_mask:0xf bank_mask:0xf
    v_and_b32_dpp v29, v39, v5 row_newbcast:12 row_mask:0xf bank_mask:0xf
    v_and_b32_dpp v30, v39, v6 row_newbcast:12 row_mask:0xf bank_mask:0xf
    v_and_b32_dpp v31, v39, v7 row_newbcast:12 row_mask:0xf bank_mask:0xf
    v_mfma_f32_16x16x32_bf16 v[48:51], v[16:19], v[224:227], v[48:51]
    v_mfma_f32_16x16x32_bf16 v[48:51], v[20:23], v[228:231], v[48:51]
    v_mfma_f32_16x16x32_bf16 v[48:51], v[24:27], v[232:235], v[48:51]
    v_mfma_f32_16x16x32_bf16 v[48:51], v[28:31], v[236:239], v[48:51]
    s_waitcnt vmcnt(6)
    s_add_u32 s66, s65, 10
    s_and_b32 s66, s66, 15
    s_lshl_b32 s66, s66, 17
    s_add_u32 s66, s66, s64
    buffer_load_dwordx4 v[72:75], v2, s[40:43], s66 offen offset:0 nt
    s_waitcnt vmcnt(6)
    buffer_load_dwordx4 v[76:79], v2, s[40:43], s66 offen offset:1024 nt
    s_waitcnt vmcnt(6)
    buffer_load_dwordx4 v[80:83], v2, s[40:43], s66 offen offset:2048 nt
    s_waitcnt vmcnt(6)
    buffer_load_dwordx4 v[84:87], v2, s[40:43], s66 offen offset:3072 nt
    v_and_b32_dpp v16, v40, v4 row_newbcast:0 row_mask:0xf bank_mask:0xf
    v_and_b32_dpp v17, v40, v5 row_newbcast:0 row_mask:0xf bank_mask:0xf
    v_and_b32_dpp v18, v40, v6 row_newbcast:0 row_mask:0xf bank_mask:0xf
    v_and_b32_dpp v19, v40, v7 row_newbcast:0 row_mask:0xf bank_mask:0xf
    v_and_b32_dpp v20, v40, v4 row_newbcast:4 row_mask:0xf bank_mask:0xf
    v_and_b32_dpp v21, v40, v5 row_newbcast:4 row_mask:0xf bank_mask:0xf
    v_and_b32_dpp v22, v40, v6 row_newbcast:4 row_mask:0xf bank_mask:0xf
    v_and_b32_dpp v23, v40, v7 row_newbcast:4 row_mask:0xf bank_mask:0xf
    v_and_b32_dpp v24, v40, v4 row_newbcast:8 row_mask:0xf bank_mask:0xf
    v_and_b32_dpp v25, v40, v5 row_newbcast:8 row_mask:0xf bank_mask:0xf
    v_and_b32_dpp v26, v40, v6 row_newbcast:8 row_mask:0xf bank_mask:0xf
    v_and_b32_dpp v27, v40, v7 row_newbcast:8 row_mask:0xf bank_mask:0xf
    v_and_b32_dpp v28, v40, v4 row_newbcast:12 row_mask:0xf bank_mask:0xf
    v_and_b32_dpp v29, v40, v5 row_newbcast:12 row_mask:0xf bank_mask:0xf
    v_and_b32_dpp v30, v40, v6 row_newbcast:12 row_mask:0xf bank_mask:0xf
    v_and_b32_dpp v31, v40, v7 row_newbcast:12 row_mask:0xf bank_mask:0xf
    v_mfma_f32_16x16x32_bf16 v[48:51], v[16:19], v[240:243], v[48:51]
    v_mfma_f32_16x16x32_bf16 v[48:51], v[20:23], v[244:247], v[48:51]
    v_mfma_f32_16x16x32_bf16 v[48:51], v[24:27], v[248:251], v[48:51]
    v_mfma_f32_16x16x32_bf16 v[48:51], v[28:31], v[252:255], v[48:51]
    s_waitcnt vmcnt(6)
    s_add_u32 s66, s65, 11
    s_and_b32 s66, s66, 15
    s_lshl_b32 s66, s66, 17
    s_add_u32 s66, s66, s64
    buffer_load_dwordx4 v[88:91], v2, s[40:43], s66 offen offset:0 nt
    s_waitcnt vmcnt(6)
    buffer_load_dwordx4 v[92:95], v2, s[40:43], s66 offen offset:1024 nt
    s_waitcnt vmcnt(6)
    buffer_load_dwordx4 v[96:99], v2, s[40:43], s66 offen offset:2048 nt
    s_waitcnt vmcnt(6)
    buffer_load_dwordx4 v[100:103], v2, s[40:43], s66 offen offset:3072 nt
    v_and_b32_dpp v16, v41, v4 row_newbcast:0 row_mask:0xf bank_mask:0xf
    v_and_b32_dpp v17, v41, v5 row_newbcast:0 row_mask:0xf bank_mask:0xf
    v_and_b32_dpp v18, v41, v6 row_newbcast:0 row_mask:0xf bank_mask:0xf
    v_and_b32_dpp v19, v41, v7 row_newbcast:0 row_mask:0xf bank_mask:0xf
    v_and_b32_dpp v20, v41, v4 row_newbcast:4 row_mask:0xf bank_mask:0xf
    v_and_b32_dpp v21, v41, v5 row_newbcast:4 row_mask:0xf bank_mask:0xf
    v_and_b32_dpp v22, v41, v6 row_newbcast:4 row_mask:0xf bank_mask:0xf
    v_and_b32_dpp v23, v41, v7 row_newbcast:4 row_mask:0xf bank_mask:0xf
    v_and_b32_dpp v24, v41, v4 row_newbcast:8 row_mask:0xf bank_mask:0xf
    v_and_b32_dpp v25, v41, v5 row_newbcast:8 row_mask:0xf bank_mask:0xf
    v_and_b32_dpp v26, v41, v6 row_newbcast:8 row_mask:0xf bank_mask:0xf
    v_and_b32_dpp v27, v41, v7 row_newbcast:8 row_mask:0xf bank_mask:0xf
    v_and_b32_dpp v28, v41, v4 row_newbcast:12 row_mask:0xf bank_mask:0xf
    v_and_b32_dpp v29, v41, v5 row_newbcast:12 row_mask:0xf bank_mask:0xf
    v_and_b32_dpp v30, v41, v6 row_newbcast:12 row_mask:0xf bank_mask:0xf
    v_and_b32_dpp v31, v41, v7 row_newbcast:12 row_mask:0xf bank_mask:0xf
    v_mfma_f32_16x16x32_bf16 v[48:51], v[16:19], v[56:59], v[48:51]
    v_mfma_f32_16x16x32_bf16 v[48:51], v[20:23], v[60:63], v[48:51]
    v_mfma_f32_16x16x32_bf16 v[48:51], v[24:27], v[64:67], v[48:51]
    v_mfma_f32_16x16x32_bf16 v[48:51], v[28:31], v[68:71], v[48:51]
    s_waitcnt vmcnt(6)
    s_add_u32 s66, s65, 12
    s_and_b32 s66, s66, 15
    s_lshl_b32 s66, s66, 17
    s_add_u32 s66, s66, s64
    buffer_load_dwordx4 v[104:107], v2, s[40:43], s66 offen offset:0 nt
    s_waitcnt vmcnt(6)
    buffer_load_dwordx4 v[108:111], v2, s[40:43], s66 offen offset:1024 nt
    s_waitcnt vmcnt(6)
    buffer_load_dwordx4 v[112:115], v2, s[40:43], s66 offen offset:2048 nt
    s_waitcnt vmcnt(6)
    buffer_load_dwordx4 v[116:119], v2, s[40:43], s66 offen offset:3072 nt
    s_waitcnt lgkmcnt(0)
    s_barrier
    v_and_b32_dpp v16, v42, v4 row_newbcast:0 row_mask:0xf bank_mask:0xf
    v_and_b32_dpp v17, v42, v5 row_newbcast:0 row_mask:0xf bank_mask:0xf
    v_and_b32_dpp v18, v42, v6 row_newbcast:0 row_mask:0xf bank_mask:0xf
    v_and_b32_dpp v19, v42, v7 row_newbcast:0 row_mask:0xf bank_mask:0xf
    v_and_b32_dpp v20, v42, v4 row_newbcast:4 row_mask:0xf bank_mask:0xf
    v_and_b32_dpp v21, v42, v5 row_newbcast:4 row_mask:0xf bank_mask:0xf
    v_and_b32_dpp v22, v42, v6 row_newbcast:4 row_mask:0xf bank_mask:0xf
    v_and_b32_dpp v23, v42, v7 row_newbcast:4 row_mask:0xf bank_mask:0xf
    v_and_b32_dpp v24, v42, v4 row_newbcast:8 row_mask:0xf bank_mask:0xf
    v_and_b32_dpp v25, v42, v5 row_newbcast:8 row_mask:0xf bank_mask:0xf
    v_and_b32_dpp v26, v42, v6 row_newbcast:8 row_mask:0xf bank_mask:0xf
    v_and_b32_dpp v27, v42, v7 row_newbcast:8 row_mask:0xf bank_mask:0xf
    v_and_b32_dpp v28, v42, v4 row_newbcast:12 row_mask:0xf bank_mask:0xf
    v_and_b32_dpp v29, v42, v5 row_newbcast:12 row_mask:0xf bank_mask:0xf
    v_and_b32_dpp v30, v42, v6 row_newbcast:12 row_mask:0xf bank_mask:0xf
    v_and_b32_dpp v31, v42, v7 row_newbcast:12 row_mask:0xf bank_mask:0xf
    v_mfma_f32_16x16x32_bf16 v[48:51], v[16:19], v[72:75], v[48:51]
    v_mfma_f32_16x16x32_bf16 v[48:51], v[20:23], v[76:79], v[48:51]
    v_mfma_f32_16x16x32_bf16 v[48:51], v[24:27], v[80:83], v[48:51]
    v_mfma_f32_16x16x32_bf16 v[48:51], v[28:31], v[84:87], v[48:51]
    s_waitcnt vmcnt(6)
    s_add_u32 s66, s65, 13
    s_and_b32 s66, s66, 15
    s_lshl_b32 s66, s66, 17
    s_add_u32 s66, s66, s64
    buffer_load_dwordx4 v[120:123], v2, s[40:43], s66 offen offset:0 nt
    s_waitcnt vmcnt(6)
    buffer_load_dwordx4 v[124:127], v2, s[40:43], s66 offen offset:1024 nt
    s_waitcnt vmcnt(6)
    buffer_load_dwordx4 v[128:131], v2, s[40:43], s66 offen offset:2048 nt
    s_waitcnt vmcnt(6)
    buffer_load_dwordx4 v[132:135], v2, s[40:43], s66 offen offset:3072 nt
    v_and_b32_dpp v16, v43, v4 row_newbcast:0 row_mask:0xf bank_mask:0xf
    v_and_b32_dpp v17, v43, v5 row_newbcast:0 row_mask:0xf bank_mask:0xf
    v_and_b32_dpp v18, v43, v6 row_newbcast:0 row_mask:0xf bank_mask:0xf
    v_and_b32_dpp v19, v43, v7 row_newbcast:0 row_mask:0xf bank_mask:0xf
    v_and_b32_dpp v20, v43, v4 row_newbcast:4 row_mask:0xf bank_mask:0xf
    v_and_b32_dpp v21, v43, v5 row_newbcast:4 row_mask:0xf bank_mask:0xf
    v_and_b32_dpp v22, v43, v6 row_newbcast:4 row_mask:0xf bank_mask:0xf
    v_and_b32_dpp v23, v43, v7 row_newbcast:4 row_mask:0xf bank_mask:0xf
    v_and_b32_dpp v24, v43, v4 row_newbcast:8 row_mask:0xf bank_mask:0xf
    v_and_b32_dpp v25, v43, v5 row_newbcast:8 row_mask:0xf bank_mask:0xf
    v_and_b32_dpp v26, v43, v6 row_newbcast:8 row_mask:0xf bank_mask:0xf
    v_and_b32_dpp v27, v43, v7 row_newbcast:8 row_mask:0xf bank_mask:0xf
    v_and_b32_dpp v28, v43, v4 row_newbcast:12 row_mask:0xf bank_mask:0xf
    v_and_b32_dpp v29, v43, v5 row_newbcast:12 row_mask:0xf bank_mask:0xf
    v_and_b32_dpp v30, v43, v6 row_newbcast:12 row_mask:0xf bank_mask:0xf
    v_and_b32_dpp v31, v43, v7 row_newbcast:12 row_mask:0xf bank_mask:0xf
    v_mfma_f32_16x16x32_bf16 v[48:51], v[16:19], v[88:91], v[48:51]
    v_mfma_f32_16x16x32_bf16 v[48:51], v[20:23], v[92:95], v[48:51]
    v_mfma_f32_16x16x32_bf16 v[48:51], v[24:27], v[96:99], v[48:51]
    v_mfma_f32_16x16x32_bf16 v[48:51], v[28:31], v[100:103], v[48:51]
    s_waitcnt vmcnt(6)
    s_add_u32 s66, s65, 14
    s_and_b32 s66, s66, 15
    s_lshl_b32 s66, s66, 17
    s_add_u32 s66, s66, s64
    buffer_load_dwordx4 v[136:139], v2, s[40:43], s66 offen offset:0 nt
    s_waitcnt vmcnt(6)
    buffer_load_dwordx4 v[140:143], v2, s[40:43], s66 offen offset:1024 nt
    s_waitcnt vmcnt(6)
    buffer_load_dwordx4 v[144:147], v2, s[40:43], s66 offen offset:2048 nt
    s_waitcnt vmcnt(6)
    buffer_load_dwordx4 v[148:151], v2, s[40:43], s66 offen offset:3072 nt
    v_and_b32_dpp v16, v44, v4 row_newbcast:0 row_mask:0xf bank_mask:0xf
    v_and_b32_dpp v17, v44, v5 row_newbcast:0 row_mask:0xf bank_mask:0xf
    v_and_b32_dpp v18, v44, v6 row_newbcast:0 row_mask:0xf bank_mask:0xf
    v_and_b32_dpp v19, v44, v7 row_newbcast:0 row_mask:0xf bank_mask:0xf
    v_and_b32_dpp v20, v44, v4 row_newbcast:4 row_mask:0xf bank_mask:0xf
    v_and_b32_dpp v21, v44, v5 row_newbcast:4 row_mask:0xf bank_mask:0xf
    v_and_b32_dpp v22, v44, v6 row_newbcast:4 row_mask:0xf bank_mask:0xf
    v_and_b32_dpp v23, v44, v7 row_newbcast:4 row_mask:0xf bank_mask:0xf
    v_and_b32_dpp v24, v44, v4 row_newbcast:8 row_mask:0xf bank_mask:0xf
    v_and_b32_dpp v25, v44, v5 row_newbcast:8 row_mask:0xf bank_mask:0xf
    v_and_b32_dpp v26, v44, v6 row_newbcast:8 row_mask:0xf bank_mask:0xf
    v_and_b32_dpp v27, v44, v7 row_newbcast:8 row_mask:0xf bank_mask:0xf
    v_and_b32_dpp v28, v44, v4 row_newbcast:12 row_mask:0xf bank_mask:0xf
    v_and_b32_dpp v29, v44, v5 row_newbcast:12 row_mask:0xf bank_mask:0xf
    v_and_b32_dpp v30, v44, v6 row_newbcast:12 row_mask:0xf bank_mask:0xf
    v_and_b32_dpp v31, v44, v7 row_newbcast:12 row_mask:0xf bank_mask:0xf
    v_mfma_f32_16x16x32_bf16 v[48:51], v[16:19], v[104:107], v[48:51]
    v_mfma_f32_16x16x32_bf16 v[48:51], v[20:23], v[108:111], v[48:51]
    v_mfma_f32_16x16x32_bf16 v[48:51], v[24:27], v[112:115], v[48:51]
    v_mfma_f32_16x16x32_bf16 v[48:51], v[28:31], v[116:119], v[48:51]
    s_waitcnt vmcnt(6)
    s_add_u32 s66, s65, 15
    s_and_b32 s66, s66, 15
    s_lshl_b32 s66, s66, 17
    s_add_u32 s66, s66, s64
    buffer_load_dwordx4 v[152:155], v2, s[40:43], s66 offen offset:0 nt
    s_waitcnt vmcnt(6)
    buffer_load_dwordx4 v[156:159], v2, s[40:43], s66 offen offset:1024 nt
    s_waitcnt vmcnt(6)
    buffer_load_dwordx4 v[160:163], v2, s[40:43], s66 offen offset:2048 nt
    s_waitcnt vmcnt(6)
    buffer_load_dwordx4 v[164:167], v2, s[40:43], s66 offen offset:3072 nt
    v_and_b32_dpp v16, v45, v4 row_newbcast:0 row_mask:0xf bank_mask:0xf
    v_and_b32_dpp v17, v45, v5 row_newbcast:0 row_mask:0xf bank_mask:0xf
    v_and_b32_dpp v18, v45, v6 row_newbcast:0 row_mask:0xf bank_mask:0xf
    v_and_b32_dpp v19, v45, v7 row_newbcast:0 row_mask:0xf bank_mask:0xf
    v_and_b32_dpp v20, v45, v4 row_newbcast:4 row_mask:0xf bank_mask:0xf
    v_and_b32_dpp v21, v45, v5 row_newbcast:4 row_mask:0xf bank_mask:0xf
    v_and_b32_dpp v22, v45, v6 row_newbcast:4 row_mask:0xf bank_mask:0xf
    v_and_b32_dpp v23, v45, v7 row_newbcast:4 row_mask:0xf bank_mask:0xf
    v_and_b32_dpp v24, v45, v4 row_newbcast:8 row_mask:0xf bank_mask:0xf
    v_and_b32_dpp v25, v45, v5 row_newbcast:8 row_mask:0xf bank_mask:0xf
    v_and_b32_dpp v26, v45, v6 row_newbcast:8 row_mask:0xf bank_mask:0xf
    v_and_b32_dpp v27, v45, v7 row_newbcast:8 row_mask:0xf bank_mask:0xf
    v_and_b32_dpp v28, v45, v4 row_newbcast:12 row_mask:0xf bank_mask:0xf
    v_and_b32_dpp v29, v45, v5 row_newbcast:12 row_mask:0xf bank_mask:0xf
    v_and_b32_dpp v30, v45, v6 row_newbcast:12 row_mask:0xf bank_mask:0xf
    v_and_b32_dpp v31, v45, v7 row_newbcast:12 row_mask:0xf bank_mask:0xf
    v_mfma_f32_16x16x32_bf16 v[48:51], v[16:19], v[120:123], v[48:51]
    v_mfma_f32_16x16x32_bf16 v[48:51], v[20:23], v[124:127], v[48:51]
    v_mfma_f32_16x16x32_bf16 v[48:51], v[24:27], v[128:131], v[48:51]
    v_mfma_f32_16x16x32_bf16 v[48:51], v[28:31], v[132:135], v[48:51]
    s_waitcnt vmcnt(4)
    v_and_b32_dpp v16, v46, v4 row_newbcast:0 row_mask:0xf bank_mask:0xf
    v_and_b32_dpp v17, v46, v5 row_newbcast:0 row_mask:0xf bank_mask:0xf
    v_and_b32_dpp v18, v46, v6 row_newbcast:0 row_mask:0xf bank_mask:0xf
    v_and_b32_dpp v19, v46, v7 row_newbcast:0 row_mask:0xf bank_mask:0xf
    v_and_b32_dpp v20, v46, v4 row_newbcast:4 row_mask:0xf bank_mask:0xf
    v_and_b32_dpp v21, v46, v5 row_newbcast:4 row_mask:0xf bank_mask:0xf
    v_and_b32_dpp v22, v46, v6 row_newbcast:4 row_mask:0xf bank_mask:0xf
    v_and_b32_dpp v23, v46, v7 row_newbcast:4 row_mask:0xf bank_mask:0xf
    v_and_b32_dpp v24, v46, v4 row_newbcast:8 row_mask:0xf bank_mask:0xf
    v_and_b32_dpp v25, v46, v5 row_newbcast:8 row_mask:0xf bank_mask:0xf
    v_and_b32_dpp v26, v46, v6 row_newbcast:8 row_mask:0xf bank_mask:0xf
    v_and_b32_dpp v27, v46, v7 row_newbcast:8 row_mask:0xf bank_mask:0xf
    v_and_b32_dpp v28, v46, v4 row_newbcast:12 row_mask:0xf bank_mask:0xf
    v_and_b32_dpp v29, v46, v5 row_newbcast:12 row_mask:0xf bank_mask:0xf
    v_and_b32_dpp v30, v46, v6 row_newbcast:12 row_mask:0xf bank_mask:0xf
    v_and_b32_dpp v31, v46, v7 row_newbcast:12 row_mask:0xf bank_mask:0xf
    v_mfma_f32_16x16x32_bf16 v[48:51], v[16:19], v[136:139], v[48:51]
    v_mfma_f32_16x16x32_bf16 v[48:51], v[20:23], v[140:143], v[48:51]
    v_mfma_f32_16x16x32_bf16 v[48:51], v[24:27], v[144:147], v[48:51]
    v_mfma_f32_16x16x32_bf16 v[48:51], v[28:31], v[148:151], v[48:51]
    s_waitcnt vmcnt(0)
    v_and_b32_dpp v16, v47, v4 row_newbcast:0 row_mask:0xf bank_mask:0xf
    v_and_b32_dpp v17, v47, v5 row_newbcast:0 row_mask:0xf bank_mask:0xf
    v_and_b32_dpp v18, v47, v6 row_newbcast:0 row_mask:0xf bank_mask:0xf
    v_and_b32_dpp v19, v47, v7 row_newbcast:0 row_mask:0xf bank_mask:0xf
    v_and_b32_dpp v20, v47, v4 row_newbcast:4 row_mask:0xf bank_mask:0xf
    v_and_b32_dpp v21, v47, v5 row_newbcast:4 row_mask:0xf bank_mask:0xf
    v_and_b32_dpp v22, v47, v6 row_newbcast:4 row_mask:0xf bank_mask:0xf
    v_and_b32_dpp v23, v47, v7 row_newbcast:4 row_mask:0xf bank_mask:0xf
    v_and_b32_dpp v24, v47, v4 row_newbcast:8 row_mask:0xf bank_mask:0xf
    v_and_b32_dpp v25, v47, v5 row_newbcast:8 row_mask:0xf bank_mask:0xf
    v_and_b32_dpp v26, v47, v6 row_newbcast:8 row_mask:0xf bank_mask:0xf
    v_and_b32_dpp v27, v47, v7 row_newbcast:8 row_mask:0xf bank_mask:0xf
    v_and_b32_dpp v28, v47, v4 row_newbcast:12 row_mask:0xf bank_mask:0xf
    v_and_b32_dpp v29, v47, v5 row_newbcast:12 row_mask:0xf bank_mask:0xf
    v_and_b32_dpp v30, v47, v6 row_newbcast:12 row_mask:0xf bank_mask:0xf
    v_and_b32_dpp v31, v47, v7 row_newbcast:12 row_mask:0xf bank_mask:0xf
    v_mfma_f32_16x16x32_bf16 v[48:51], v[16:19], v[152:155], v[48:51]
    v_mfma_f32_16x16x32_bf16 v[48:51], v[20:23], v[156:159], v[48:51]
    v_mfma_f32_16x16x32_bf16 v[48:51], v[24:27], v[160:163], v[48:51]
    v_mfma_f32_16x16x32_bf16 v[48:51], v[28:31], v[164:167], v[48:51]
    v_and_b32 v8, 15, v0
    v_lshlrev_b32 v8, 5, v8
    v_bfe_u32 v9, v0, 4, 1
    v_lshlrev_b32 v9, 4, v9
    s_lshl_b32 s79, s28, 9
    v_add3_u32 v8, v8, v9, s79
    s_nop 1
    ds_write_b128 v8, v[48:51] offset:512
    s_waitcnt lgkmcnt(0)
    s_barrier
    s_endpgm
L_help:
    s_setprio 3
    v_and_b32 v8, 15, v0
    v_lshrrev_b32 v9, 4, v0
    v_lshlrev_b32 v14, 2, v8
    v_add_u32 v14, v14, v9
    v_lshlrev_b32 v14, 1, v14
    v_lshlrev_b32 v10, 13, v9
    v_lshlrev_b32 v11, 4, v8
    v_add_u32 v3, v10, v11
    s_lshl_b32 s79, s30, 7
    s_lshl_b32 s78, s30, 19
    s_lshl_b32 s80, s29, 8
    s_add_u32 s78, s78, s80
    s_and_b32 s80, s2, 7
    s_lshl_b32 s80, s80, 7
    s_waitcnt lgkmcnt(0)
    s_mov_b32 s80, s79
    s_mov_b32 s32, s4
    s_and_b32 s33, s5, 0xffff
    s_mov_b32 s34, 0x400
    s_mov_b32 s35, 0x20000
    s_mov_b32 s44, s10
    s_and_b32 s45, s11, 0xffff
    s_mov_b32 s46, 0x400000
    s_mov_b32 s47, 0x20000
    buffer_load_dwordx4 v[16:19], v2, s[32:35], 0 offen
    buffer_load_ushort v12, v14, s[32:35], s79 offen
    buffer_load_ushort v13, v14, s[32:35], s80 offen
    buffer_load_dwordx4 v[64:67], v3, s[44:47], s78 offen
    s_add_u32 s78, s78, 32768
    buffer_load_dwordx4 v[68:71], v3, s[44:47], s78 offen
    s_add_u32 s78, s78, 32768
    buffer_load_dwordx4 v[72:75], v3, s[44:47], s78 offen
    s_add_u32 s78, s78, 32768
    buffer_load_dwordx4 v[76:79], v3, s[44:47], s78 offen
    s_add_u32 s78, s78, 32768
    buffer_load_dwordx4 v[80:83], v3, s[44:47], s78 offen
    s_add_u32 s78, s78, 32768
    buffer_load_dwordx4 v[84:87], v3, s[44:47], s78 offen
    s_add_u32 s78, s78, 32768
    buffer_load_dwordx4 v[88:91], v3, s[44:47], s78 offen
    s_add_u32 s78, s78, 32768
    buffer_load_dwordx4 v[92:95], v3, s[44:47], s78 offen
    s_add_u32 s78, s78, 32768
    buffer_load_dwordx4 v[96:99], v3, s[44:47], s78 offen
    s_add_u32 s78, s78, 32768
    buffer_load_dwordx4 v[100:103], v3, s[44:47], s78 offen
    s_add_u32 s78, s78, 32768
    buffer_load_dwordx4 v[104:107], v3, s[44:47], s78 offen
    s_add_u32 s78, s78, 32768
    buffer_load_dwordx4 v[108:111], v3, s[44:47], s78 offen
    s_add_u32 s78, s78, 32768
    buffer_load_dwordx4 v[112:115], v3, s[44:47], s78 offen
    s_add_u32 s78, s78, 32768
    buffer_load_dwordx4 v[116:119], v3, s[44:47], s78 offen
    s_add_u32 s78, s78, 32768
    buffer_load_dwordx4 v[120:123], v3, s[44:47], s78 offen
    s_add_u32 s78, s78, 32768
    buffer_load_dwordx4 v[124:127], v3, s[44:47], s78 offen
    s_add_u32 s78, s78, 32768
    s_load_dword s31, s[26:27], 4
    s_and_b32 s14, s2, 7
    s_lshl_b32 s14, s14, 3
    s_mov_b32 s80, 0xb070400
    s_mov_b32 s81, 0x1511110d
    s_mov_b32 s82, 0x2040304
    s_mov_b32 s83, 0x1040004
    s_lshr_b64 s[80:81], s[80:81], s14
    s_lshr_b64 s[82:83], s[82:83], s14
    s_and_b32 s80, s80, 0xff
    s_and_b32 s82, s82, 0xff
    s_lshr_b32 s79, s2, 6
    s_add_u32 s14, s80, s79
    s_cmp_ge_u32 s79, s82
    s_cselect_b32 s14, 99, s14
    s_mov_b32 s15, s30
    s_mov_b32 s52, s26
    s_and_b32 s53, s27, 0xffff
    s_mov_b32 s54, 0x400000
    s_mov_b32 s55, 0x20000
    v_and_b32 v10, 1, v0
    v_lshlrev_b32 v10, 4, v10
    v_mov_b32 v11, 0xffff
    v_lshlrev_b32 v10, v10, v11
    v_bfe_u32 v11, v0, 1, 2
    v_cmp_eq_u32 s[80:81], 0, v11
    v_cmp_eq_u32 s[82:83], 1, v11
    s_nop 0
    v_cndmask_b32 v4, 0, v10, s[80:81]
    v_cndmask_b32 v5, 0, v10, s[82:83]
    v_cmp_eq_u32 s[80:81], 2, v11
    v_cmp_eq_u32 s[82:83], 3, v11
    s_nop 0
    v_cndmask_b32 v6, 0, v10, s[80:81]
    v_cndmask_b32 v7, 0, v10, s[82:83]
    s_waitcnt vmcnt(16)
    v_lshlrev_b32 v20, 16, v16
    v_and_b32 v21, 0xffff0000, v16
    v_lshlrev_b32 v22, 16, v17
    v_and_b32 v23, 0xffff0000, v17
    v_lshlrev_b32 v24, 16, v18
    v_and_b32 v25, 0xffff0000, v18
    v_lshlrev_b32 v26, 16, v19
    v_and_b32 v27, 0xffff0000, v19
    v_add_f32 v28, v20, v21
    v_add_f32 v29, v22, v23
    v_add_f32 v30, v24, v25
    v_add_f32 v31, v26, v27
    v_add_f32 v28, v28, v29
    v_add_f32 v30, v30, v31
    v_add_f32 v28, v28, v30
    s_nop 1
    v_add_f32_dpp v28, v28, v28 quad_perm:[1,0,3,2] row_mask:0xf bank_mask:0xf
    s_nop 1
    v_add_f32_dpp v28, v28, v28 quad_perm:[2,3,0,1] row_mask:0xf bank_mask:0xf
    s_nop 1
    v_add_f32_dpp v28, v28, v28 row_half_mirror row_mask:0xf bank_mask:0xf
    s_nop 1
    v_add_f32_dpp v28, v28, v28 row_mirror row_mask:0xf bank_mask:0xf
    v_mov_b32 v29, v28
    s_nop 1
    v_permlane16_swap_b32 v29, v28
    v_add_f32 v28, v28, v29
    v_mov_b32 v29, v28
    s_nop 1
    v_permlane32_swap_b32 v29, v28
    v_add_f32 v28, v28, v29
    v_mul_f32 v28, 0x3b000000, v28
    v_sub_f32 v20, v20, v28
    v_sub_f32 v21, v21, v28
    v_sub_f32 v22, v22, v28
    v_sub_f32 v23, v23, v28
    v_sub_f32 v24, v24, v28
    v_sub_f32 v25, v25, v28
    v_sub_f32 v26, v26, v28
    v_sub_f32 v27, v27, v28
    v_mul_f32 v30, v20, v20
    v_mul_f32 v31, v21, v21
    v_fmac_f32 v30, v22, v22
    v_fmac_f32 v31, v23, v23
    v_fmac_f32 v30, v24, v24
    v_fmac_f32 v31, v25, v25
    v_fmac_f32 v30, v26, v26
    v_fmac_f32 v31, v27, v27
    v_add_f32 v30, v30, v31
    s_nop 1
    v_add_f32_dpp v30, v30, v30 quad_perm:[1,0,3,2] row_mask:0xf bank_mask:0xf
    s_nop 1
    v_add_f32_dpp v30, v30, v30 quad_perm:[2,3,0,1] row_mask:0xf bank_mask:0xf
    s_nop 1
    v_add_f32_dpp v30, v30, v30 row_half_mirror row_mask:0xf bank_mask:0xf
    s_nop 1
    v_add_f32_dpp v30, v30, v30 row_mirror row_mask:0xf bank_mask:0xf
    v_mov_b32 v29, v30
    s_nop 1
    v_permlane16_swap_b32 v29, v30
    v_add_f32 v30, v30, v29
    v_mov_b32 v29, v30
    s_nop 1
    v_permlane32_swap_b32 v29, v30
    v_add_f32 v30, v30, v29
    v_mul_f32 v30, 0x3b000000, v30
    v_cvt_pk_bf16_f32 v28, v28, v28
    v_and_b32 v28, 0xffff0000, v28
    v_cvt_pk_bf16_f32 v30, v30, v30
    v_and_b32 v30, 0xffff0000, v30
    v_add_f32 v30, 0x3727c5ac, v30
    v_cvt_pk_bf16_f32 v30, v30, v30
    v_and_b32 v30, 0xffff0000, v30
    v_sqrt_f32 v30, v30
    s_nop 0
    v_cvt_pk_bf16_f32 v30, v30, v30
    v_and_b32 v30, 0xffff0000, v30
    v_rcp_f32 v31, v30
    v_lshlrev_b32 v12, 16, v12
    v_lshlrev_b32 v13, 16, v13
    v_sub_f32 v12, v12, v28
    v_sub_f32 v13, v13, v28
    v_cvt_pk_bf16_f32 v12, v12, v12
    v_cvt_pk_bf16_f32 v13, v13, v13
    v_and_b32 v12, 0xffff0000, v12
    v_and_b32 v13, 0xffff0000, v13
    v_mul_f32 v20, v12, v31
    v_mul_f32 v22, v13, v31
    v_fma_f32 v21, -v20, v30, v12
    v_fma_f32 v23, -v22, v30, v13
    v_fma_f32 v20, v21, v31, v20
    v_fma_f32 v22, v23, v31, v22
    v_cvt_pk_bf16_f32 v12, v20, v20
    v_cvt_pk_bf16_f32 v13, v22, v22
    s_waitcnt vmcnt(12)
    v_and_b32_dpp v32, v12, v4 row_newbcast:0 row_mask:0xf bank_mask:0xf
    v_and_b32_dpp v33, v12, v5 row_newbcast:0 row_mask:0xf bank_mask:0xf
    v_and_b32_dpp v34, v12, v6 row_newbcast:0 row_mask:0xf bank_mask:0xf
    v_and_b32_dpp v35, v12, v7 row_newbcast:0 row_mask:0xf bank_mask:0xf
    v_and_b32_dpp v36, v12, v4 row_newbcast:1 row_mask:0xf bank_mask:0xf
    v_and_b32_dpp v37, v12, v5 row_newbcast:1 row_mask:0xf bank_mask:0xf
    v_and_b32_dpp v38, v12, v6 row_newbcast:1 row_mask:0xf bank_mask:0xf
    v_and_b32_dpp v39, v12, v7 row_newbcast:1 row_mask:0xf bank_mask:0xf
    v_and_b32_dpp v40, v12, v4 row_newbcast:2 row_mask:0xf bank_mask:0xf
    v_and_b32_dpp v41, v12, v5 row_newbcast:2 row_mask:0xf bank_mask:0xf
    v_and_b32_dpp v42, v12, v6 row_newbcast:2 row_mask:0xf bank_mask:0xf
    v_and_b32_dpp v43, v12, v7 row_newbcast:2 row_mask:0xf bank_mask:0xf
    v_and_b32_dpp v44, v12, v4 row_newbcast:3 row_mask:0xf bank_mask:0xf
    v_and_b32_dpp v45, v12, v5 row_newbcast:3 row_mask:0xf bank_mask:0xf
    v_and_b32_dpp v46, v12, v6 row_newbcast:3 row_mask:0xf bank_mask:0xf
    v_and_b32_dpp v47, v12, v7 row_newbcast:3 row_mask:0xf bank_mask:0xf
    v_mfma_f32_16x16x32_bf16 v[48:51], v[32:35], v[64:67], 0
    v_mfma_f32_16x16x32_bf16 v[48:51], v[36:39], v[68:71], v[48:51]
    v_mfma_f32_16x16x32_bf16 v[48:51], v[40:43], v[72:75], v[48:51]
    v_mfma_f32_16x16x32_bf16 v[48:51], v[44:47], v[76:79], v[48:51]
    s_waitcnt vmcnt(8)
    v_and_b32_dpp v32, v12, v4 row_newbcast:4 row_mask:0xf bank_mask:0xf
    v_and_b32_dpp v33, v12, v5 row_newbcast:4 row_mask:0xf bank_mask:0xf
    v_and_b32_dpp v34, v12, v6 row_newbcast:4 row_mask:0xf bank_mask:0xf
    v_and_b32_dpp v35, v12, v7 row_newbcast:4 row_mask:0xf bank_mask:0xf
    v_and_b32_dpp v36, v12, v4 row_newbcast:5 row_mask:0xf bank_mask:0xf
    v_and_b32_dpp v37, v12, v5 row_newbcast:5 row_mask:0xf bank_mask:0xf
    v_and_b32_dpp v38, v12, v6 row_newbcast:5 row_mask:0xf bank_mask:0xf
    v_and_b32_dpp v39, v12, v7 row_newbcast:5 row_mask:0xf bank_mask:0xf
    v_and_b32_dpp v40, v12, v4 row_newbcast:6 row_mask:0xf bank_mask:0xf
    v_and_b32_dpp v41, v12, v5 row_newbcast:6 row_mask:0xf bank_mask:0xf
    v_and_b32_dpp v42, v12, v6 row_newbcast:6 row_mask:0xf bank_mask:0xf
    v_and_b32_dpp v43, v12, v7 row_newbcast:6 row_mask:0xf bank_mask:0xf
    v_and_b32_dpp v44, v12, v4 row_newbcast:7 row_mask:0xf bank_mask:0xf
    v_and_b32_dpp v45, v12, v5 row_newbcast:7 row_mask:0xf bank_mask:0xf
    v_and_b32_dpp v46, v12, v6 row_newbcast:7 row_mask:0xf bank_mask:0xf
    v_and_b32_dpp v47, v12, v7 row_newbcast:7 row_mask:0xf bank_mask:0xf
    v_mfma_f32_16x16x32_bf16 v[48:51], v[32:35], v[80:83], v[48:51]
    v_mfma_f32_16x16x32_bf16 v[48:51], v[36:39], v[84:87], v[48:51]
    v_mfma_f32_16x16x32_bf16 v[48:51], v[40:43], v[88:91], v[48:51]
    v_mfma_f32_16x16x32_bf16 v[48:51], v[44:47], v[92:95], v[48:51]
    s_waitcnt vmcnt(4)
    v_and_b32_dpp v32, v12, v4 row_newbcast:8 row_mask:0xf bank_mask:0xf
    v_and_b32_dpp v33, v12, v5 row_newbcast:8 row_mask:0xf bank_mask:0xf
    v_and_b32_dpp v34, v12, v6 row_newbcast:8 row_mask:0xf bank_mask:0xf
    v_and_b32_dpp v35, v12, v7 row_newbcast:8 row_mask:0xf bank_mask:0xf
    v_and_b32_dpp v36, v12, v4 row_newbcast:9 row_mask:0xf bank_mask:0xf
    v_and_b32_dpp v37, v12, v5 row_newbcast:9 row_mask:0xf bank_mask:0xf
    v_and_b32_dpp v38, v12, v6 row_newbcast:9 row_mask:0xf bank_mask:0xf
    v_and_b32_dpp v39, v12, v7 row_newbcast:9 row_mask:0xf bank_mask:0xf
    v_and_b32_dpp v40, v12, v4 row_newbcast:10 row_mask:0xf bank_mask:0xf
    v_and_b32_dpp v41, v12, v5 row_newbcast:10 row_mask:0xf bank_mask:0xf
    v_and_b32_dpp v42, v12, v6 row_newbcast:10 row_mask:0xf bank_mask:0xf
    v_and_b32_dpp v43, v12, v7 row_newbcast:10 row_mask:0xf bank_mask:0xf
    v_and_b32_dpp v44, v12, v4 row_newbcast:11 row_mask:0xf bank_mask:0xf
    v_and_b32_dpp v45, v12, v5 row_newbcast:11 row_mask:0xf bank_mask:0xf
    v_and_b32_dpp v46, v12, v6 row_newbcast:11 row_mask:0xf bank_mask:0xf
    v_and_b32_dpp v47, v12, v7 row_newbcast:11 row_mask:0xf bank_mask:0xf
    v_mfma_f32_16x16x32_bf16 v[48:51], v[32:35], v[96:99], v[48:51]
    v_mfma_f32_16x16x32_bf16 v[48:51], v[36:39], v[100:103], v[48:51]
    v_mfma_f32_16x16x32_bf16 v[48:51], v[40:43], v[104:107], v[48:51]
    v_mfma_f32_16x16x32_bf16 v[48:51], v[44:47], v[108:111], v[48:51]
    s_waitcnt vmcnt(0)
    v_and_b32_dpp v32, v12, v4 row_newbcast:12 row_mask:0xf bank_mask:0xf
    v_and_b32_dpp v33, v12, v5 row_newbcast:12 row_mask:0xf bank_mask:0xf
    v_and_b32_dpp v34, v12, v6 row_newbcast:12 row_mask:0xf bank_mask:0xf
    v_and_b32_dpp v35, v12, v7 row_newbcast:12 row_mask:0xf bank_mask:0xf
    v_and_b32_dpp v36, v12, v4 row_newbcast:13 row_mask:0xf bank_mask:0xf
    v_and_b32_dpp v37, v12, v5 row_newbcast:13 row_mask:0xf bank_mask:0xf
    v_and_b32_dpp v38, v12, v6 row_newbcast:13 row_mask:0xf bank_mask:0xf
    v_and_b32_dpp v39, v12, v7 row_newbcast:13 row_mask:0xf bank_mask:0xf
    v_and_b32_dpp v40, v12, v4 row_newbcast:14 row_mask:0xf bank_mask:0xf
    v_and_b32_dpp v41, v12, v5 row_newbcast:14 row_mask:0xf bank_mask:0xf
    v_and_b32_dpp v42, v12, v6 row_newbcast:14 row_mask:0xf bank_mask:0xf
    v_and_b32_dpp v43, v12, v7 row_newbcast:14 row_mask:0xf bank_mask:0xf
    v_and_b32_dpp v44, v12, v4 row_newbcast:15 row_mask:0xf bank_mask:0xf
    v_and_b32_dpp v45, v12, v5 row_newbcast:15 row_mask:0xf bank_mask:0xf
    v_and_b32_dpp v46, v12, v6 row_newbcast:15 row_mask:0xf bank_mask:0xf
    v_and_b32_dpp v47, v12, v7 row_newbcast:15 row_mask:0xf bank_mask:0xf
    v_mfma_f32_16x16x32_bf16 v[48:51], v[32:35], v[112:115], v[48:51]
    v_mfma_f32_16x16x32_bf16 v[48:51], v[36:39], v[116:119], v[48:51]
    v_mfma_f32_16x16x32_bf16 v[48:51], v[40:43], v[120:123], v[48:51]
    v_mfma_f32_16x16x32_bf16 v[48:51], v[44:47], v[124:127], v[48:51]
    s_waitcnt lgkmcnt(0)
    s_add_u32 s31, s31, 0x9e3779b1
    s_lshl_b32 s80, s29, 13
    s_add_u32 s80, s80, 65536
    s_lshl_b32 s79, s30, 10
    s_add_u32 s81, s80, s79
    s_mov_b32 s82, 0
    s_mov_b32 s83, -1
    v_mov_b32 v17, s31
    v_mov_b32 v19, s31
    v_cndmask_b32 v16, v48, v50, s[82:83]
    v_cndmask_b32 v18, v49, v51, s[82:83]
    buffer_store_dwordx4 v[16:19], v2, s[52:55], s81 offen
    v_and_b32 v14, 7, v0
    v_lshlrev_b32 v14, 10, v14
    s_mov_b32 s66, 200000
    s_mov_b32 s67, 0
    s_mov_b64 exec, 0xff
L_lq:
    buffer_load_dwordx4 v[52:55], v14, s[52:55], s80 offen offset:1008 sc1
    s_waitcnt vmcnt(0)
    v_xor_b32 v8, s31, v53
    v_xor_b32 v9, s31, v55
    v_or_b32 v8, v8, v9
    v_cmp_ne_u32 vcc, 0, v8
    s_nop 1
    s_cmp_lg_u64 vcc, 0
    s_cbranch_scc0 L_lq_ok
    s_sleep 2
    s_sub_u32 s66, s66, 1
    s_cmp_lg_u32 s66, 199997
    s_cbranch_scc1 L_lq_nofb
    s_add_u32 s79, s81, 0x200000
    s_mov_b64 exec, -1
    buffer_store_dwordx4 v[16:19], v2, s[52:55], s79 offen sc1
    s_mov_b64 exec, 255
    s_mov_b32 s67, 0x200000
L_lq_nofb:
    s_xor_b32 s80, s80, s67
    s_cmp_lg_u32 s66, 0
    s_cbranch_scc1 L_lq
L_lq_ok:
    s_mov_b64 exec, -1
    s_add_u32 s4, s80, 0
    s_add_u32 s5, s80, 4096
    s_mov_b32 s66, 200000
L_pq:
    buffer_load_dwordx4 v[64:67], v2, s[52:55], s4 offen offset:0 sc1
    buffer_load_dwordx4 v[68:71], v2, s[52:55], s4 offen offset:1024 sc1
    buffer_load_dwordx4 v[72:75], v2, s[52:55], s4 offen offset:2048 sc1
    buffer_load_dwordx4 v[76:79], v2, s[52:55], s4 offen offset:3072 sc1
    buffer_load_dwordx4 v[80:83], v2, s[52:55], s5 offen offset:0 sc1
    buffer_load_dwordx4 v[84:87], v2, s[52:55], s5 offen offset:1024 sc1
    buffer_load_dwordx4 v[88:91], v2, s[52:55], s5 offen offset:2048 sc1
    buffer_load_dwordx4 v[92:95], v2, s[52:55], s5 offen offset:3072 sc1
    s_waitcnt vmcnt(0)
    v_xor_b32 v8, s31, v65
    v_xor_b32 v9, s31, v67
    v_xor_b32 v10, s31, v69
    v_xor_b32 v11, s31, v71
    v_or3_b32 v8, v8, v10, v11
    v_xor_b32 v10, s31, v73
    v_xor_b32 v11, s31, v75
    v_or3_b32 v8, v8, v10, v11
    v_xor_b32 v10, s31, v77
    v_xor_b32 v11, s31, v79
    v_or3_b32 v8, v8, v10, v11
    v_xor_b32 v10, s31, v81
    v_xor_b32 v11, s31, v83
    v_or3_b32 v8, v8, v10, v11
    v_xor_b32 v10, s31, v85
    v_xor_b32 v11, s31, v87
    v_or3_b32 v8, v8, v10, v11
    v_xor_b32 v10, s31, v89
    v_xor_b32 v11, s31, v91
    v_or3_b32 v8, v8, v10, v11
    v_xor_b32 v10, s31, v93
    v_xor_b32 v11, s31, v95
    v_or3_b32 v8, v8, v10, v11
    v_or_b32 v8, v8, v9
    v_cmp_ne_u32 vcc, 0, v8
    s_nop 1
    s_cmp_lg_u64 vcc, 0
    s_cbranch_scc0 L_pq_ok
    s_sleep 2
    s_sub_u32 s66, s66, 1
    s_cmp_lg_u32 s66, 0
    s_cbranch_scc1 L_pq
L_pq_ok:
    s_cmp_lg_u32 s67, 0
    s_cbranch_scc1 L_q_hasb
    s_add_u32 s79, s81, 0x200000
    s_mov_b64 exec, -1
    buffer_store_dwordx4 v[16:19], v2, s[52:55], s79 offen sc1
    s_mov_b64 exec, -1
L_q_hasb:
    v_add_f32 v64, v64, v68
    v_add_f32 v72, v72, v76
    v_add_f32 v80, v80, v84
    v_add_f32 v88, v88, v92
    v_add_f32 v64, v64, v72
    v_add_f32 v80, v80, v88
    v_add_f32 v16, v64, v80
    v_add_f32 v66, v66, v70
    v_add_f32 v74, v74, v78
    v_add_f32 v82, v82, v86
    v_add_f32 v90, v90, v94
    v_add_f32 v66, v66, v74
    v_add_f32 v82, v82, v90
    v_add_f32 v17, v66, v82
    v_cvt_pk_bf16_f32 v16, v16, v17
    v_and_b32 v8, 15, v0
    v_lshlrev_b32 v8, 4, v8
    v_bfe_u32 v9, v0, 4, 1
    v_lshlrev_b32 v9, 3, v9
    v_lshrrev_b32 v10, 5, v0
    v_lshlrev_b32 v10, 2, v10
    v_add3_u32 v8, v8, v9, v10
    ds_write_b32 v8, v16 offset:0
    s_waitcnt lgkmcnt(0)
    s_barrier
L_afterq:
    s_setprio 0
    v_lshrrev_b32 v8, 3, v0
    v_lshlrev_b32 v8, 10, v8
    v_and_b32 v9, 7, v0
    v_lshlrev_b32 v9, 4, v9
    v_add_u32 v3, v8, v9
    s_cmp_ge_u32 s14, 22
    s_cbranch_scc1 L_noffn
    s_mov_b32 s60, s20
    s_and_b32 s61, s21, 0xffff
    s_mov_b32 s62, 0x158000
    s_mov_b32 s63, 0x20000
    s_mov_b32 s80, 0xff00ff00
    s_mov_b32 s81, 0xff00ff00
    v_mov_b32 v10, s16
    v_mov_b32 v11, s17
    v_mov_b32 v20, s18
    v_mov_b32 v21, s19
    v_cndmask_b32 v10, v10, v20, s[80:81]
    v_cndmask_b32 v11, v11, v21, s[80:81]
    s_cmp_eq_u32 s14, 21
    s_cselect_b32 s79, 3, 7
    v_and_b32 v20, s79, v0
    v_lshlrev_b32 v20, 4, v20
    s_mul_i32 s79, s15, 176128
    s_lshl_b32 s80, s14, 7
    s_add_u32 s79, s79, s80
    v_lshrrev_b32 v21, 4, v0
    v_mul_u32_u24 v21, 2752, v21
    v_add3_u32 v20, v20, v21, s79
    v_add_co_u32 v10, vcc, v10, v20
    s_nop 1
    v_addc_co_u32 v11, vcc, 0, v11, vcc
    s_mov_b32 s80, 11008
    s_mov_b32 s81, 0
    global_load_dwordx4 v[64:67], v[10:11], off
    v_lshl_add_u64 v[10:11], v[10:11], 0, s[80:81]
    global_load_dwordx4 v[68:71], v[10:11], off
    v_lshl_add_u64 v[10:11], v[10:11], 0, s[80:81]
    global_load_dwordx4 v[72:75], v[10:11], off
    v_lshl_add_u64 v[10:11], v[10:11], 0, s[80:81]
    global_load_dwordx4 v[76:79], v[10:11], off
    v_lshl_add_u64 v[10:11], v[10:11], 0, s[80:81]
    global_load_dwordx4 v[80:83], v[10:11], off
    v_lshl_add_u64 v[10:11], v[10:11], 0, s[80:81]
    global_load_dwordx4 v[84:87], v[10:11], off
    v_lshl_add_u64 v[10:11], v[10:11], 0, s[80:81]
    global_load_dwordx4 v[88:91], v[10:11], off
    v_lshl_add_u64 v[10:11], v[10:11], 0, s[80:81]
    global_load_dwordx4 v[92:95], v[10:11], off
    v_lshl_add_u64 v[10:11], v[10:11], 0, s[80:81]
    global_load_dwordx4 v[96:99], v[10:11], off
    v_lshl_add_u64 v[10:11], v[10:11], 0, s[80:81]
    global_load_dwordx4 v[100:103], v[10:11], off
    v_lshl_add_u64 v[10:11], v[10:11], 0, s[80:81]
    global_load_dwordx4 v[104:107], v[10:11], off
    v_lshl_add_u64 v[10:11], v[10:11], 0, s[80:81]
    global_load_dwordx4 v[108:111], v[10:11], off
    v_lshl_add_u64 v[10:11], v[10:11], 0, s[80:81]
    global_load_dwordx4 v[112:115], v[10:11], off
    v_lshl_add_u64 v[10:11], v[10:11], 0, s[80:81]
    global_load_dwordx4 v[116:119], v[10:11], off
    v_lshl_add_u64 v[10:11], v[10:11], 0, s[80:81]
    global_load_dwordx4 v[120:123], v[10:11], off
    v_lshl_add_u64 v[10:11], v[10:11], 0, s[80:81]
    global_load_dwordx4 v[124:127], v[10:11], off
    v_lshl_add_u64 v[10:11], v[10:11], 0, s[80:81]
    s_lshl_b32 s78, s14, 16
    s_lshl_b32 s79, s15, 7
    s_add_u32 s78, s78, s79
    s_waitcnt vmcnt(12)
    v_and_b32_dpp v32, v13, v4 row_newbcast:0 row_mask:0xf bank_mask:0xf
    v_and_b32_dpp v33, v13, v5 row_newbcast:0 row_mask:0xf bank_mask:0xf
    v_and_b32_dpp v34, v13, v6 row_newbcast:0 row_mask:0xf bank_mask:0xf
    v_and_b32_dpp v35, v13, v7 row_newbcast:0 row_mask:0xf bank_mask:0xf
    v_and_b32_dpp v36, v13, v4 row_newbcast:1 row_mask:0xf bank_mask:0xf
    v_and_b32_dpp v37, v13, v5 row_newbcast:1 row_mask:0xf bank_mask:0xf
    v_and_b32_dpp v38, v13, v6 row_newbcast:1 row_mask:0xf bank_mask:0xf
    v_and_b32_dpp v39, v13, v7 row_newbcast:1 row_mask:0xf bank_mask:0xf
    v_and_b32_dpp v40, v13, v4 row_newbcast:2 row_mask:0xf bank_mask:0xf
    v_and_b32_dpp v41, v13, v5 row_newbcast:2 row_mask:0xf bank_mask:0xf
    v_and_b32_dpp v42, v13, v6 row_newbcast:2 row_mask:0xf bank_mask:0xf
    v_and_b32_dpp v43, v13, v7 row_newbcast:2 row_mask:0xf bank_mask:0xf
    v_and_b32_dpp v44, v13, v4 row_newbcast:3 row_mask:0xf bank_mask:0xf
    v_and_b32_dpp v45, v13, v5 row_newbcast:3 row_mask:0xf bank_mask:0xf
    v_and_b32_dpp v46, v13, v6 row_newbcast:3 row_mask:0xf bank_mask:0xf
    v_and_b32_dpp v47, v13, v7 row_newbcast:3 row_mask:0xf bank_mask:0xf
    v_mfma_f32_16x16x32_bf16 v[48:51], v[32:35], v[64:67], 0
    v_mfma_f32_16x16x32_bf16 v[48:51], v[36:39], v[68:71], v[48:51]
    v_mfma_f32_16x16x32_bf16 v[48:51], v[40:43], v[72:75], v[48:51]
    v_mfma_f32_16x16x32_bf16 v[48:51], v[44:47], v[76:79], v[48:51]
    s_waitcnt vmcnt(8)
    v_and_b32_dpp v32, v13, v4 row_newbcast:4 row_mask:0xf bank_mask:0xf
    v_and_b32_dpp v33, v13, v5 row_newbcast:4 row_mask:0xf bank_mask:0xf
    v_and_b32_dpp v34, v13, v6 row_newbcast:4 row_mask:0xf bank_mask:0xf
    v_and_b32_dpp v35, v13, v7 row_newbcast:4 row_mask:0xf bank_mask:0xf
    v_and_b32_dpp v36, v13, v4 row_newbcast:5 row_mask:0xf bank_mask:0xf
    v_and_b32_dpp v37, v13, v5 row_newbcast:5 row_mask:0xf bank_mask:0xf
    v_and_b32_dpp v38, v13, v6 row_newbcast:5 row_mask:0xf bank_mask:0xf
    v_and_b32_dpp v39, v13, v7 row_newbcast:5 row_mask:0xf bank_mask:0xf
    v_and_b32_dpp v40, v13, v4 row_newbcast:6 row_mask:0xf bank_mask:0xf
    v_and_b32_dpp v41, v13, v5 row_newbcast:6 row_mask:0xf bank_mask:0xf
    v_and_b32_dpp v42, v13, v6 row_newbcast:6 row_mask:0xf bank_mask:0xf
    v_and_b32_dpp v43, v13, v7 row_newbcast:6 row_mask:0xf bank_mask:0xf
    v_and_b32_dpp v44, v13, v4 row_newbcast:7 row_mask:0xf bank_mask:0xf
    v_and_b32_dpp v45, v13, v5 row_newbcast:7 row_mask:0xf bank_mask:0xf
    v_and_b32_dpp v46, v13, v6 row_newbcast:7 row_mask:0xf bank_mask:0xf
    v_and_b32_dpp v47, v13, v7 row_newbcast:7 row_mask:0xf bank_mask:0xf
    v_mfma_f32_16x16x32_bf16 v[48:51], v[32:35], v[80:83], v[48:51]
    v_mfma_f32_16x16x32_bf16 v[48:51], v[36:39], v[84:87], v[48:51]
    v_mfma_f32_16x16x32_bf16 v[48:51], v[40:43], v[88:91], v[48:51]
    v_mfma_f32_16x16x32_bf16 v[48:51], v[44:47], v[92:95], v[48:51]
    s_waitcnt vmcnt(4)
    v_and_b32_dpp v32, v13, v4 row_newbcast:8 row_mask:0xf bank_mask:0xf
    v_and_b32_dpp v33, v13, v5 row_newbcast:8 row_mask:0xf bank_mask:0xf
    v_and_b32_dpp v34, v13, v6 row_newbcast:8 row_mask:0xf bank_mask:0xf
    v_and_b32_dpp v35, v13, v7 row_newbcast:8 row_mask:0xf bank_mask:0xf
    v_and_b32_dpp v36, v13, v4 row_newbcast:9 row_mask:0xf bank_mask:0xf
    v_and_b32_dpp v37, v13, v5 row_newbcast:9 row_mask:0xf bank_mask:0xf
    v_and_b32_dpp v38, v13, v6 row_newbcast:9 row_mask:0xf bank_mask:0xf
    v_and_b32_dpp v39, v13, v7 row_newbcast:9 row_mask:0xf bank_mask:0xf
    v_and_b32_dpp v40, v13, v4 row_newbcast:10 row_mask:0xf bank_mask:0xf
    v_and_b32_dpp v41, v13, v5 row_newbcast:10 row_mask:0xf bank_mask:0xf
    v_and_b32_dpp v42, v13, v6 row_newbcast:10 row_mask:0xf bank_mask:0xf
    v_and_b32_dpp v43, v13, v7 row_newbcast:10 row_mask:0xf bank_mask:0xf
    v_and_b32_dpp v44, v13, v4 row_newbcast:11 row_mask:0xf bank_mask:0xf
    v_and_b32_dpp v45, v13, v5 row_newbcast:11 row_mask:0xf bank_mask:0xf
    v_and_b32_dpp v46, v13, v6 row_newbcast:11 row_mask:0xf bank_mask:0xf
    v_and_b32_dpp v47, v13, v7 row_newbcast:11 row_mask:0xf bank_mask:0xf
    v_mfma_f32_16x16x32_bf16 v[48:51], v[32:35], v[96:99], v[48:51]
    v_mfma_f32_16x16x32_bf16 v[48:51], v[36:39], v[100:103], v[48:51]
    v_mfma_f32_16x16x32_bf16 v[48:51], v[40:43], v[104:107], v[48:51]
    v_mfma_f32_16x16x32_bf16 v[48:51], v[44:47], v[108:111], v[48:51]
    s_waitcnt vmcnt(0)
    v_and_b32_dpp v32, v13, v4 row_newbcast:12 row_mask:0xf bank_mask:0xf
    v_and_b32_dpp v33, v13, v5 row_newbcast:12 row_mask:0xf bank_mask:0xf
    v_and_b32_dpp v34, v13, v6 row_newbcast:12 row_mask:0xf bank_mask:0xf
    v_and_b32_dpp v35, v13, v7 row_newbcast:12 row_mask:0xf bank_mask:0xf
    v_and_b32_dpp v36, v13, v4 row_newbcast:13 row_mask:0xf bank_mask:0xf
    v_and_b32_dpp v37, v13, v5 row_newbcast:13 row_mask:0xf bank_mask:0xf
    v_and_b32_dpp v38, v13, v6 row_newbcast:13 row_mask:0xf bank_mask:0xf
    v_and_b32_dpp v39, v13, v7 row_newbcast:13 row_mask:0xf bank_mask:0xf
    v_and_b32_dpp v40, v13, v4 row_newbcast:14 row_mask:0xf bank_mask:0xf
    v_and_b32_dpp v41, v13, v5 row_newbcast:14 row_mask:0xf bank_mask:0xf
    v_and_b32_dpp v42, v13, v6 row_newbcast:14 row_mask:0xf bank_mask:0xf
    v_and_b32_dpp v43, v13, v7 row_newbcast:14 row_mask:0xf bank_mask:0xf
    v_and_b32_dpp v44, v13, v4 row_newbcast:15 row_mask:0xf bank_mask:0xf
    v_and_b32_dpp v45, v13, v5 row_newbcast:15 row_mask:0xf bank_mask:0xf
    v_and_b32_dpp v46, v13, v6 row_newbcast:15 row_mask:0xf bank_mask:0xf
    v_and_b32_dpp v47, v13, v7 row_newbcast:15 row_mask:0xf bank_mask:0xf
    v_mfma_f32_16x16x32_bf16 v[48:51], v[32:35], v[112:115], v[48:51]
    v_mfma_f32_16x16x32_bf16 v[48:51], v[36:39], v[116:119], v[48:51]
    v_mfma_f32_16x16x32_bf16 v[48:51], v[40:43], v[120:123], v[48:51]
    v_mfma_f32_16x16x32_bf16 v[48:51], v[44:47], v[124:127], v[48:51]
    s_lshl_b32 s80, s14, 13
    s_add_u32 s80, s80, 327680
    s_lshl_b32 s79, s15, 10
    s_add_u32 s81, s80, s79
    s_mov_b32 s82, 0
    s_mov_b32 s83, -1
    s_mov_b32 s4, 0xff00ff00
    s_mov_b32 s5, 0xff00ff00
    v_cndmask_b32 v16, v48, v50, s[82:83]
    v_cndmask_b32 v17, v49, v51, s[82:83]
    v_mov_b32 v21, s31
    v_mov_b32 v23, s31
    v_mov_b32_dpp v18, v16 row_ror:8 row_mask:0xf bank_mask:0xf
    v_mov_b32_dpp v19, v17 row_ror:8 row_mask:0xf bank_mask:0xf
    v_cndmask_b32 v20, v16, v19, s[4:5]
    v_cndmask_b32 v22, v18, v17, s[4:5]
    buffer_store_dwordx4 v[20:23], v2, s[52:55], s81 offen
    buffer_load_dwordx4 v[128:131], v3, s[60:63], s78 offen
    s_add_u32 s78, s78, 8192
    buffer_load_dwordx4 v[132:135], v3, s[60:63], s78 offen
    s_add_u32 s78, s78, 8192
    buffer_load_dwordx4 v[136:139], v3, s[60:63], s78 offen
    s_add_u32 s78, s78, 8192
    buffer_load_dwordx4 v[140:143], v3, s[60:63], s78 offen
    s_add_u32 s78, s78, 8192
    buffer_load_dwordx4 v[144:147], v3, s[60:63], s78 offen
    s_add_u32 s78, s78, 8192
    buffer_load_dwordx4 v[148:151], v3, s[60:63], s78 offen
    s_add_u32 s78, s78, 8192
    buffer_load_dwordx4 v[152:155], v3, s[60:63], s78 offen
    s_add_u32 s78, s78, 8192
    buffer_load_dwordx4 v[156:159], v3, s[60:63], s78 offen
    s_add_u32 s78, s78, 8192
    v_and_b32 v14, 7, v0
    v_lshlrev_b32 v14, 10, v14
    s_mov_b32 s66, 200000
    s_mov_b32 s67, 0
    s_mov_b64 exec, 0xff
L_lg:
    buffer_load_dwordx4 v[52:55], v14, s[52:55], s80 offen offset:1008 sc1
    s_waitcnt vmcnt(0)
    v_xor_b32 v8, s31, v53
    v_xor_b32 v9, s31, v55
    v_or_b32 v8, v8, v9
    v_cmp_ne_u32 vcc, 0, v8
    s_nop 1
    s_cmp_lg_u64 vcc, 0
    s_cbranch_scc0 L_lg_ok
    s_sleep 16
    s_sub_u32 s66, s66, 1
    s_cmp_lg_u32 s66, 199997
    s_cbranch_scc1 L_lg_nofb
    s_add_u32 s79, s81, 0x200000
    s_mov_b64 exec, -1
    buffer_store_dwordx4 v[20:23], v2, s[52:55], s79 offen sc1
    s_mov_b64 exec, 255
    s_mov_b32 s67, 0x200000
L_lg_nofb:
    s_xor_b32 s80, s80, s67
    s_cmp_lg_u32 s66, 0
    s_cbranch_scc1 L_lg
L_lg_ok:
    s_mov_b64 exec, -1
    s_add_u32 s4, s80, 0
    s_add_u32 s5, s80, 4096
    s_mov_b32 s66, 200000
L_pg:
    buffer_load_dwordx4 v[64:67], v2, s[52:55], s4 offen offset:0 sc1
    buffer_load_dwordx4 v[68:71], v2, s[52:55], s4 offen offset:1024 sc1
    buffer_load_dwordx4 v[72:75], v2, s[52:55], s4 offen offset:2048 sc1
    buffer_load_dwordx4 v[76:79], v2, s[52:55], s4 offen offset:3072 sc1
    buffer_load_dwordx4 v[80:83], v2, s[52:55], s5 offen offset:0 sc1
    buffer_load_dwordx4 v[84:87], v2, s[52:55], s5 offen offset:1024 sc1
    buffer_load_dwordx4 v[88:91], v2, s[52:55], s5 offen offset:2048 sc1
    buffer_load_dwordx4 v[92:95], v2, s[52:55], s5 offen offset:3072 sc1
    s_waitcnt vmcnt(0)
    v_xor_b32 v8, s31, v65
    v_xor_b32 v9, s31, v67
    v_xor_b32 v10, s31, v69
    v_xor_b32 v11, s31, v71
    v_or3_b32 v8, v8, v10, v11
    v_xor_b32 v10, s31, v73
    v_xor_b32 v11, s31, v75
    v_or3_b32 v8, v8, v10, v11
    v_xor_b32 v10, s31, v77
    v_xor_b32 v11, s31, v79
    v_or3_b32 v8, v8, v10, v11
    v_xor_b32 v10, s31, v81
    v_xor_b32 v11, s31, v83
    v_or3_b32 v8, v8, v10, v11
    v_xor_b32 v10, s31, v85
    v_xor_b32 v11, s31, v87
    v_or3_b32 v8, v8, v10, v11
    v_xor_b32 v10, s31, v89
    v_xor_b32 v11, s31, v91
    v_or3_b32 v8, v8, v10, v11
    v_xor_b32 v10, s31, v93
    v_xor_b32 v11, s31, v95
    v_or3_b32 v8, v8, v10, v11
    v_or_b32 v8, v8, v9
    v_cmp_ne_u32 vcc, 0, v8
    s_nop 1
    s_cmp_lg_u64 vcc, 0
    s_cbranch_scc0 L_pg_ok
    s_sleep 16
    s_sub_u32 s66, s66, 1
    s_cmp_lg_u32 s66, 0
    s_cbranch_scc1 L_pg
L_pg_ok:
    s_cmp_lg_u32 s67, 0
    s_cbranch_scc1 L_g_hasb
    s_add_u32 s79, s81, 0x200000
    s_mov_b64 exec, -1
    buffer_store_dwordx4 v[20:23], v2, s[52:55], s79 offen sc1
    s_mov_b64 exec, -1
L_g_hasb:
    v_add_f32 v64, v64, v68
    v_add_f32 v72, v72, v76
    v_add_f32 v80, v80, v84
    v_add_f32 v88, v88, v92
    v_add_f32 v64, v64, v72
    v_add_f32 v80, v80, v88
    v_add_f32 v16, v64, v80
    v_add_f32 v66, v66, v70
    v_add_f32 v74, v74, v78
    v_add_f32 v82, v82, v86
    v_add_f32 v90, v90, v94
    v_add_f32 v66, v66, v74
    v_add_f32 v82, v82, v90
    v_add_f32 v20, v66, v82
    v_cvt_pk_bf16_f32 v16, v16, v16
    v_and_b32 v16, 0xffff0000, v16
    v_cvt_pk_bf16_f32 v20, v20, v20
    v_and_b32 v20, 0xffff0000, v20
    v_mul_f32 v17, v16, v16
    v_mov_b32 v18, 0x3f4c422a
    v_fmac_f32 v18, 0x3d122279, v17
    v_mul_f32 v18, v18, v16
    v_mul_f32 v18, 0xc038aa3b, v18
    v_exp_f32 v18, v18
    v_bfe_u32 v8, v0, 4, 1
    v_add_f32 v18, 1.0, v18
    v_rcp_f32 v18, v18
    v_lshlrev_b32 v8, 2, v8
    v_mul_f32 v16, v16, v18
    v_lshrrev_b32 v9, 5, v0
    v_lshlrev_b32 v9, 1, v9
    v_bfe_u32 v10, v0, 3, 1
    v_add3_u32 v8, v8, v9, v10
    v_and_b32 v9, 7, v0
    v_cvt_pk_bf16_f32 v16, v16, v16
    v_and_b32 v16, 0xffff0000, v16
    v_mul_f32 v16, v16, v20
    v_cvt_pk_bf16_f32 v16, v16, v16
    v_lshlrev_b32 v10, 3, v9
    s_lshl_b32 s79, s14, 6
    v_add3_u32 v10, v10, v8, s79
    v_cmp_gt_u32 vcc, 1376, v10
    s_nop 1
    v_cndmask_b32 v16, 0, v16, vcc
    v_lshl_add_u32 v8, v8, 3, v9
    v_lshlrev_b32 v8, 2, v8
    ds_write_b32 v8, v16 offset:2688
    v_lshrrev_b32 v9, 3, v0
    v_lshlrev_b32 v9, 5, v9
    s_waitcnt lgkmcnt(0)
    ds_read_b128 v[24:27], v9 offset:2688
    ds_read_b128 v[28:31], v9 offset:2704
    s_waitcnt lgkmcnt(0)
    v_and_b32 v32, v24, v4
    v_and_b32 v33, v24, v5
    v_and_b32 v34, v24, v6
    v_and_b32 v35, v24, v7
    v_and_b32 v36, v25, v4
    v_and_b32 v37, v25, v5
    v_and_b32 v38, v25, v6
    v_and_b32 v39, v25, v7
    v_and_b32 v40, v26, v4
    v_and_b32 v41, v26, v5
    v_and_b32 v42, v26, v6
    v_and_b32 v43, v26, v7
    v_and_b32 v44, v27, v4
    v_and_b32 v45, v27, v5
    v_and_b32 v46, v27, v6
    v_and_b32 v47, v27, v7
    v_mfma_f32_16x16x32_bf16 v[48:51], v[32:35], v[128:131], 0
    v_mfma_f32_16x16x32_bf16 v[48:51], v[36:39], v[132:135], v[48:51]
    v_mfma_f32_16x16x32_bf16 v[48:51], v[40:43], v[136:139], v[48:51]
    v_mfma_f32_16x16x32_bf16 v[48:51], v[44:47], v[140:143], v[48:51]
    v_and_b32 v32, v28, v4
    v_and_b32 v33, v28, v5
    v_and_b32 v34, v28, v6
    v_and_b32 v35, v28, v7
    v_and_b32 v36, v29, v4
    v_and_b32 v37, v29, v5
    v_and_b32 v38, v29, v6
    v_and_b32 v39, v29, v7
    v_and_b32 v40, v30, v4
    v_and_b32 v41, v30, v5
    v_and_b32 v42, v30, v6
    v_and_b32 v43, v30, v7
    v_and_b32 v44, v31, v4
    v_and_b32 v45, v31, v5
    v_and_b32 v46, v31, v6
    v_and_b32 v47, v31, v7
    v_mfma_f32_16x16x32_bf16 v[48:51], v[32:35], v[144:147], v[48:51]
    v_mfma_f32_16x16x32_bf16 v[48:51], v[36:39], v[148:151], v[48:51]
    v_mfma_f32_16x16x32_bf16 v[48:51], v[40:43], v[152:155], v[48:51]
    v_mfma_f32_16x16x32_bf16 v[48:51], v[44:47], v[156:159], v[48:51]
    s_branch L_ffndone
L_noffn:
    s_nop 6
    v_mov_b32 v48, 0
    v_mov_b32 v49, 0
    v_mov_b32 v50, 0
    v_mov_b32 v51, 0
L_ffndone:
    s_nop 7
    s_setprio 3
    v_mov_b32 v9, 0
    s_lshl_b32 s80, s29, 14
    s_add_u32 s80, s80, 524288
    s_lshl_b32 s79, s30, 11
    s_add_u32 s81, s80, s79
    v_mov_b32 v37, s31
    v_mov_b32 v39, s31
    v_and_b32 v14, 7, v0
    v_lshlrev_b32 v14, 11, v14
    s_barrier
    ds_read_b128 v[24:27], v9 offset:2560
    ds_read_b128 v[28:31], v9 offset:2576
    s_waitcnt lgkmcnt(0)
    v_max3_f32 v36, v24, v26, v28
    v_max_f32 v36, v36, v30
    v_sub_f32 v24, v24, v36
    v_sub_f32 v26, v26, v36
    v_sub_f32 v28, v28, v36
    v_sub_f32 v30, v30, v36
    v_mul_f32 v24, s77, v24
    v_mul_f32 v26, s77, v26
    v_mul_f32 v28, s77, v28
    v_mul_f32 v30, s77, v30
    v_exp_f32 v24, v24
    v_exp_f32 v26, v26
    v_exp_f32 v28, v28
    v_exp_f32 v30, v30
    v_mul_f32 v38, v24, v25
    v_fmac_f32 v38, v26, v27
    v_fmac_f32 v38, v28, v29
    v_fmac_f32 v38, v30, v31
    s_mov_b64 exec, 0xff
    buffer_store_dwordx4 v[36:39], v2, s[52:55], s81 offen offset:1024
    buffer_load_dwordx4 v[52:55], v14, s[52:55], s80 offen offset:1024 sc1
    s_mov_b64 exec, -1
    s_mov_b32 s48, s12
    s_and_b32 s49, s13, 0xffff
    s_mov_b32 s50, 0x400000
    s_mov_b32 s51, 0x20000
    s_lshl_b32 s78, s29, 17
    s_lshl_b32 s79, s30, 7
    s_add_u32 s78, s78, s79
    buffer_load_dwordx4 v[96:99], v3, s[48:51], s78 offen
    s_add_u32 s78, s78, 8192
    buffer_load_dwordx4 v[100:103], v3, s[48:51], s78 offen
    s_add_u32 s78, s78, 8192
    buffer_load_dwordx4 v[104:107], v3, s[48:51], s78 offen
    s_add_u32 s78, s78, 8192
    buffer_load_dwordx4 v[108:111], v3, s[48:51], s78 offen
    s_add_u32 s78, s78, 8192
    buffer_load_dwordx4 v[112:115], v3, s[48:51], s78 offen
    s_add_u32 s78, s78, 8192
    buffer_load_dwordx4 v[116:119], v3, s[48:51], s78 offen
    s_add_u32 s78, s78, 8192
    buffer_load_dwordx4 v[120:123], v3, s[48:51], s78 offen
    s_add_u32 s78, s78, 8192
    buffer_load_dwordx4 v[124:127], v3, s[48:51], s78 offen
    s_add_u32 s78, s78, 8192
    buffer_load_dwordx4 v[128:131], v3, s[48:51], s78 offen
    s_add_u32 s78, s78, 8192
    buffer_load_dwordx4 v[132:135], v3, s[48:51], s78 offen
    s_add_u32 s78, s78, 8192
    buffer_load_dwordx4 v[136:139], v3, s[48:51], s78 offen
    s_add_u32 s78, s78, 8192
    buffer_load_dwordx4 v[140:143], v3, s[48:51], s78 offen
    s_add_u32 s78, s78, 8192
    buffer_load_dwordx4 v[144:147], v3, s[48:51], s78 offen
    s_add_u32 s78, s78, 8192
    buffer_load_dwordx4 v[148:151], v3, s[48:51], s78 offen
    s_add_u32 s78, s78, 8192
    buffer_load_dwordx4 v[152:155], v3, s[48:51], s78 offen
    s_add_u32 s78, s78, 8192
    buffer_load_dwordx4 v[156:159], v3, s[48:51], s78 offen
    s_add_u32 s78, s78, 8192
    s_mov_b32 s66, 200000
    s_mov_b32 s67, 0
    s_mov_b64 exec, 0xff
    s_waitcnt vmcnt(16)
    s_branch L_pm_chk
L_pm:
    buffer_load_dwordx4 v[52:55], v14, s[52:55], s80 offen offset:1024 sc1
    s_waitcnt vmcnt(0)
L_pm_chk:
    v_xor_b32 v8, s31, v53
    v_xor_b32 v9, s31, v55
    v_or_b32 v8, v8, v9
    v_cmp_ne_u32 vcc, 0, v8
    s_nop 1
    s_cmp_lg_u64 vcc, 0
    s_cbranch_scc0 L_pm_ok
    s_sleep 2
    s_sub_u32 s66, s66, 1
    s_cmp_lg_u32 s66, 199994
    s_cbranch_scc1 L_pm_nofb
    s_add_u32 s79, s81, 0x200000
    s_mov_b64 exec, 255
    buffer_store_dwordx4 v[36:39], v2, s[52:55], s79 offen offset:1024 sc1
    s_mov_b64 exec, 255
    s_mov_b32 s67, 0x200000
L_pm_nofb:
    s_xor_b32 s80, s80, s67
    s_cmp_lg_u32 s66, 0
    s_cbranch_scc1 L_pm
L_pm_ok:
    s_mov_b64 exec, -1
    s_cmp_lg_u32 s67, 0
    s_cbranch_scc1 L_m_hasb
    s_add_u32 s79, s81, 0x200000
    s_mov_b64 exec, 255
    buffer_store_dwordx4 v[36:39], v2, s[52:55], s79 offen offset:1024 sc1
    s_mov_b64 exec, -1
L_m_hasb:
    v_mov_b32 v16, v52
    s_nop 1
    v_max_f32_dpp v16, v16, v16 quad_perm:[1,0,3,2] row_mask:0xf bank_mask:0xf
    s_nop 1
    v_max_f32_dpp v16, v16, v16 quad_perm:[2,3,0,1] row_mask:0xf bank_mask:0xf
    s_nop 1
    v_max_f32_dpp v16, v16, v16 row_half_mirror row_mask:0xf bank_mask:0xf
    v_sub_f32 v16, v52, v16
    v_mul_f32 v16, s77, v16
    v_exp_f32 v16, v16
    s_nop 0
    v_mul_f32 v17, v16, v54
    s_nop 1
    v_add_f32_dpp v17, v17, v17 quad_perm:[1,0,3,2] row_mask:0xf bank_mask:0xf
    s_nop 1
    v_add_f32_dpp v17, v17, v17 quad_perm:[2,3,0,1] row_mask:0xf bank_mask:0xf
    s_nop 1
    v_add_f32_dpp v17, v17, v17 row_half_mirror row_mask:0xf bank_mask:0xf
    v_rcp_f32 v17, v17
    s_nop 0
    v_mul_f32 v16, v16, v17
    s_nop 0
    v_readlane_b32 s4, v16, s30
    s_nop 1
    v_mul_f32 v24, s4, v24
    v_mul_f32 v26, s4, v26
    v_mul_f32 v28, s4, v28
    v_mul_f32 v30, s4, v30
    s_mov_b32 s56, s22
    s_and_b32 s57, s23, 0xffff
    s_mov_b32 s58, 0x400
    s_mov_b32 s59, 0x20000
    v_and_b32 v8, 15, v0
    v_lshrrev_b32 v9, 4, v0
    s_lshl_b32 s80, s30, 6
    s_lshr_b32 s79, s29, 3
    s_lshl_b32 s79, s79, 4
    s_add_u32 s80, s80, s79
    v_add_u32 v8, s80, v8
    v_lshlrev_b32 v56, 1, v8
    v_lshlrev_b32 v8, 3, v8
    v_lshlrev_b32 v10, 15, v9
    v_add_u32 v57, v10, v8
    s_and_b32 s79, s29, 7
    s_cmp_lg_u32 s79, s30
    s_cbranch_scc1 L_nored
    buffer_load_ushort v58, v56, s[32:35], 0 offen
L_nored:
    v_and_b32 v8, 7, v0
    v_lshlrev_b32 v8, 4, v8
    v_lshrrev_b32 v9, 3, v0
    v_add_u32 v8, v8, v9
    v_lshlrev_b32 v8, 2, v8
    v_add_u32 v10, 512, v8
    v_add_u32 v11, 1536, v8
    s_lshl_b32 s80, s29, 14
    s_add_u32 s80, s80, 524288
    s_lshl_b32 s79, s30, 11
    s_add_u32 s81, s80, s79
    v_mov_b32 v33, s31
    v_mov_b32 v35, s31
    s_barrier
    ds_read2_b32 v[16:17], v10 offset0:0 offset1:8
    ds_read2_b32 v[18:19], v10 offset0:128 offset1:136
    ds_read2_b32 v[20:21], v11 offset0:0 offset1:8
    ds_read2_b32 v[22:23], v11 offset0:128 offset1:136
    s_waitcnt lgkmcnt(3)
    v_mul_f32 v32, v24, v16
    v_mul_f32 v34, v24, v17
    s_waitcnt lgkmcnt(2)
    v_fmac_f32 v32, v26, v18
    v_fmac_f32 v34, v26, v19
    s_waitcnt lgkmcnt(1)
    v_fmac_f32 v32, v28, v20
    v_fmac_f32 v34, v28, v21
    s_waitcnt lgkmcnt(0)
    v_fmac_f32 v32, v30, v22
    v_fmac_f32 v34, v30, v23
    buffer_store_dwordx4 v[32:35], v2, s[52:55], s81 offen
    s_add_u32 s4, s80, 0
    s_add_u32 s5, s80, 4096
    s_add_u32 s6, s80, 8192
    s_add_u32 s7, s80, 12288
    s_mov_b32 s66, 200000
    s_mov_b32 s67, 0
    buffer_load_dwordx4 v[64:67], v2, s[52:55], s4 offen offset:0 sc1
    buffer_load_dwordx4 v[68:71], v2, s[52:55], s4 offen offset:2048 sc1
    buffer_load_dwordx4 v[72:75], v2, s[52:55], s5 offen offset:0 sc1
    buffer_load_dwordx4 v[76:79], v2, s[52:55], s5 offen offset:2048 sc1
    buffer_load_dwordx4 v[80:83], v2, s[52:55], s6 offen offset:0 sc1
    buffer_load_dwordx4 v[84:87], v2, s[52:55], s6 offen offset:2048 sc1
    buffer_load_dwordx4 v[88:91], v2, s[52:55], s7 offen offset:0 sc1
    buffer_load_dwordx4 v[92:95], v2, s[52:55], s7 offen offset:2048 sc1
    s_waitcnt vmcnt(0)
    v_xor_b32 v8, s31, v65
    v_xor_b32 v9, s31, v67
    v_xor_b32 v10, s31, v69
    v_xor_b32 v11, s31, v71
    v_or3_b32 v8, v8, v10, v11
    v_xor_b32 v10, s31, v73
    v_xor_b32 v11, s31, v75
    v_or3_b32 v8, v8, v10, v11
    v_xor_b32 v10, s31, v77
    v_xor_b32 v11, s31, v79
    v_or3_b32 v8, v8, v10, v11
    v_xor_b32 v10, s31, v81
    v_xor_b32 v11, s31, v83
    v_or3_b32 v8, v8, v10, v11
    v_xor_b32 v10, s31, v85
    v_xor_b32 v11, s31, v87
    v_or3_b32 v8, v8, v10, v11
    v_xor_b32 v10, s31, v89
    v_xor_b32 v11, s31, v91
    v_or3_b32 v8, v8, v10, v11
    v_xor_b32 v10, s31, v93
    v_xor_b32 v11, s31, v95
    v_or3_b32 v8, v8, v10, v11
    v_or_b32 v8, v8, v9
    v_cmp_ne_u32 vcc, 0, v8
    s_nop 1
    s_cmp_lg_u64 vcc, 0
    s_cbranch_scc0 L_po_a
    buffer_load_dwordx4 v[160:163], v2, s[52:55], s4 offen offset:0 sc1
    buffer_load_dwordx4 v[164:167], v2, s[52:55], s4 offen offset:2048 sc1
    buffer_load_dwordx4 v[168:171], v2, s[52:55], s5 offen offset:0 sc1
    buffer_load_dwordx4 v[172:175], v2, s[52:55], s5 offen offset:2048 sc1
    buffer_load_dwordx4 v[176:179], v2, s[52:55], s6 offen offset:0 sc1
    buffer_load_dwordx4 v[180:183], v2, s[52:55], s6 offen offset:2048 sc1
    buffer_load_dwordx4 v[184:187], v2, s[52:55], s7 offen offset:0 sc1
    buffer_load_dwordx4 v[188:191], v2, s[52:55], s7 offen offset:2048 sc1
L_po:
    buffer_load_dwordx4 v[64:67], v2, s[52:55], s4 offen offset:0 sc1
    buffer_load_dwordx4 v[68:71], v2, s[52:55], s4 offen offset:2048 sc1
    buffer_load_dwordx4 v[72:75], v2, s[52:55], s5 offen offset:0 sc1
    buffer_load_dwordx4 v[76:79], v2, s[52:55], s5 offen offset:2048 sc1
    buffer_load_dwordx4 v[80:83], v2, s[52:55], s6 offen offset:0 sc1
    buffer_load_dwordx4 v[84:87], v2, s[52:55], s6 offen offset:2048 sc1
    buffer_load_dwordx4 v[88:91], v2, s[52:55], s7 offen offset:0 sc1
    buffer_load_dwordx4 v[92:95], v2, s[52:55], s7 offen offset:2048 sc1
    s_waitcnt vmcnt(8)
    v_xor_b32 v8, s31, v161
    v_xor_b32 v9, s31, v163
    v_xor_b32 v10, s31, v165
    v_xor_b32 v11, s31, v167
    v_or3_b32 v8, v8, v10, v11
    v_xor_b32 v10, s31, v169
    v_xor_b32 v11, s31, v171
    v_or3_b32 v8, v8, v10, v11
    v_xor_b32 v10, s31, v173
    v_xor_b32 v11, s31, v175
    v_or3_b32 v8, v8, v10, v11
    v_xor_b32 v10, s31, v177
    v_xor_b32 v11, s31, v179
    v_or3_b32 v8, v8, v10, v11
    v_xor_b32 v10, s31, v181
    v_xor_b32 v11, s31, v183
    v_or3_b32 v8, v8, v10, v11
    v_xor_b32 v10, s31, v185
    v_xor_b32 v11, s31, v187
    v_or3_b32 v8, v8, v10, v11
    v_xor_b32 v10, s31, v189
    v_xor_b32 v11, s31, v191
    v_or3_b32 v8, v8, v10, v11
    v_or_b32 v8, v8, v9
    v_cmp_ne_u32 vcc, 0, v8
    s_nop 1
    s_cmp_lg_u64 vcc, 0
    s_cbranch_scc0 L_po_b
    buffer_load_dwordx4 v[160:163], v2, s[52:55], s4 offen offset:0 sc1
    buffer_load_dwordx4 v[164:167], v2, s[52:55], s4 offen offset:2048 sc1
    buffer_load_dwordx4 v[168:171], v2, s[52:55], s5 offen offset:0 sc1
    buffer_load_dwordx4 v[172:175], v2, s[52:55], s5 offen offset:2048 sc1
    buffer_load_dwordx4 v[176:179], v2, s[52:55], s6 offen offset:0 sc1
    buffer_load_dwordx4 v[180:183], v2, s[52:55], s6 offen offset:2048 sc1
    buffer_load_dwordx4 v[184:187], v2, s[52:55], s7 offen offset:0 sc1
    buffer_load_dwordx4 v[188:191], v2, s[52:55], s7 offen offset:2048 sc1
    s_waitcnt vmcnt(8)
    v_xor_b32 v8, s31, v65
    v_xor_b32 v9, s31, v67
    v_xor_b32 v10, s31, v69
    v_xor_b32 v11, s31, v71
    v_or3_b32 v8, v8, v10, v11
    v_xor_b32 v10, s31, v73
    v_xor_b32 v11, s31, v75
    v_or3_b32 v8, v8, v10, v11
    v_xor_b32 v10, s31, v77
    v_xor_b32 v11, s31, v79
    v_or3_b32 v8, v8, v10, v11
    v_xor_b32 v10, s31, v81
    v_xor_b32 v11, s31, v83
    v_or3_b32 v8, v8, v10, v11
    v_xor_b32 v10, s31, v85
    v_xor_b32 v11, s31, v87
    v_or3_b32 v8, v8, v10, v11
    v_xor_b32 v10, s31, v89
    v_xor_b32 v11, s31, v91
    v_or3_b32 v8, v8, v10, v11
    v_xor_b32 v10, s31, v93
    v_xor_b32 v11, s31, v95
    v_or3_b32 v8, v8, v10, v11
    v_or_b32 v8, v8, v9
    v_cmp_ne_u32 vcc, 0, v8
    s_nop 1
    s_cmp_lg_u64 vcc, 0
    s_cbranch_scc0 L_po_a
    s_sub_u32 s66, s66, 1
    s_cmp_lg_u32 s66, 199988
    s_cbranch_scc1 L_po_nofb
    s_add_u32 s79, s81, 0x200000
    s_mov_b64 exec, -1
    buffer_store_dwordx4 v[32:35], v2, s[52:55], s79 offen sc1
    s_mov_b64 exec, -1
    s_mov_b32 s67, 0x200000
L_po_nofb:
    s_xor_b32 s80, s80, s67
    s_xor_b32 s4, s4, s67
    s_xor_b32 s5, s5, s67
    s_xor_b32 s6, s6, s67
    s_xor_b32 s7, s7, s67
    s_cmp_lg_u32 s66, 0
    s_cbranch_scc1 L_po
L_po_b:
    s_cmp_lg_u32 s67, 0
    s_cbranch_scc1 L_ob_hasb
    s_add_u32 s79, s81, 0x200000
    s_mov_b64 exec, -1
    buffer_store_dwordx4 v[32:35], v2, s[52:55], s79 offen sc1
    s_mov_b64 exec, -1
L_ob_hasb:
    v_add_f32 v160, v160, v164
    v_add_f32 v168, v168, v172
    v_add_f32 v176, v176, v180
    v_add_f32 v184, v184, v188
    v_add_f32 v160, v160, v168
    v_add_f32 v176, v176, v184
    v_add_f32 v18, v160, v176
    v_add_f32 v162, v162, v166
    v_add_f32 v170, v170, v174
    v_add_f32 v178, v178, v182
    v_add_f32 v186, v186, v190
    v_add_f32 v162, v162, v170
    v_add_f32 v178, v178, v186
    v_add_f32 v19, v162, v178
    s_branch L_po_w
L_po_a:
    s_cmp_lg_u32 s67, 0
    s_cbranch_scc1 L_o_hasb
    s_add_u32 s79, s81, 0x200000
    s_mov_b64 exec, -1
    buffer_store_dwordx4 v[32:35], v2, s[52:55], s79 offen sc1
    s_mov_b64 exec, -1
L_o_hasb:
    v_add_f32 v64, v64, v68
    v_add_f32 v72, v72, v76
    v_add_f32 v80, v80, v84
    v_add_f32 v88, v88, v92
    v_add_f32 v64, v64, v72
    v_add_f32 v80, v80, v88
    v_add_f32 v18, v64, v80
    v_add_f32 v66, v66, v70
    v_add_f32 v74, v74, v78
    v_add_f32 v82, v82, v86
    v_add_f32 v90, v90, v94
    v_add_f32 v66, v66, v74
    v_add_f32 v82, v82, v90
    v_add_f32 v19, v66, v82
L_po_w:
    s_nop 1
    v_lshlrev_b32 v8, 3, v0
    v_lshrrev_b32 v9, 3, v0
    v_lshlrev_b32 v9, 6, v9
    v_cvt_pk_bf16_f32 v18, v18, v18
    v_cvt_pk_bf16_f32 v19, v19, v19
    ds_write_b64 v8, v[18:19] offset:2688
    s_lshl_b32 s80, s29, 12
    s_lshl_b32 s79, s30, 9
    s_add_u32 s80, s80, s79
    s_add_u32 s80, s80, 1048576
    s_waitcnt lgkmcnt(0)
    ds_read_b128 v[16:19], v9 offset:2688
    ds_read_b128 v[20:23], v9 offset:2704
    ds_read_b128 v[24:27], v9 offset:2720
    ds_read_b128 v[28:31], v9 offset:2736
    s_waitcnt lgkmcnt(3)
    v_and_b32 v32, v16, v4
    v_and_b32 v33, v16, v5
    v_and_b32 v34, v16, v6
    v_and_b32 v35, v16, v7
    v_and_b32 v36, v17, v4
    v_and_b32 v37, v17, v5
    v_and_b32 v38, v17, v6
    v_and_b32 v39, v17, v7
    v_and_b32 v40, v18, v4
    v_and_b32 v41, v18, v5
    v_and_b32 v42, v18, v6
    v_and_b32 v43, v18, v7
    v_and_b32 v44, v19, v4
    v_and_b32 v45, v19, v5
    v_and_b32 v46, v19, v6
    v_and_b32 v47, v19, v7
    v_mfma_f32_16x16x32_bf16 v[48:51], v[32:35], v[96:99], v[48:51]
    v_mfma_f32_16x16x32_bf16 v[48:51], v[36:39], v[100:103], v[48:51]
    v_mfma_f32_16x16x32_bf16 v[48:51], v[40:43], v[104:107], v[48:51]
    v_mfma_f32_16x16x32_bf16 v[48:51], v[44:47], v[108:111], v[48:51]
    s_waitcnt lgkmcnt(2)
    v_and_b32 v32, v20, v4
    v_and_b32 v33, v20, v5
    v_and_b32 v34, v20, v6
    v_and_b32 v35, v20, v7
    v_and_b32 v36, v21, v4
    v_and_b32 v37, v21, v5
    v_and_b32 v38, v21, v6
    v_and_b32 v39, v21, v7
    v_and_b32 v40, v22, v4
    v_and_b32 v41, v22, v5
    v_and_b32 v42, v22, v6
    v_and_b32 v43, v22, v7
    v_and_b32 v44, v23, v4
    v_and_b32 v45, v23, v5
    v_and_b32 v46, v23, v6
    v_and_b32 v47, v23, v7
    v_mfma_f32_16x16x32_bf16 v[48:51], v[32:35], v[112:115], v[48:51]
    v_mfma_f32_16x16x32_bf16 v[48:51], v[36:39], v[116:119], v[48:51]
    v_mfma_f32_16x16x32_bf16 v[48:51], v[40:43], v[120:123], v[48:51]
    v_mfma_f32_16x16x32_bf16 v[48:51], v[44:47], v[124:127], v[48:51]
    s_waitcnt lgkmcnt(1)
    v_and_b32 v32, v24, v4
    v_and_b32 v33, v24, v5
    v_and_b32 v34, v24, v6
    v_and_b32 v35, v24, v7
    v_and_b32 v36, v25, v4
    v_and_b32 v37, v25, v5
    v_and_b32 v38, v25, v6
    v_and_b32 v39, v25, v7
    v_and_b32 v40, v26, v4
    v_and_b32 v41, v26, v5
    v_and_b32 v42, v26, v6
    v_and_b32 v43, v26, v7
    v_and_b32 v44, v27, v4
    v_and_b32 v45, v27, v5
    v_and_b32 v46, v27, v6
    v_and_b32 v47, v27, v7
    v_mfma_f32_16x16x32_bf16 v[48:51], v[32:35], v[128:131], v[48:51]
    v_mfma_f32_16x16x32_bf16 v[48:51], v[36:39], v[132:135], v[48:51]
    v_mfma_f32_16x16x32_bf16 v[48:51], v[40:43], v[136:139], v[48:51]
    v_mfma_f32_16x16x32_bf16 v[48:51], v[44:47], v[140:143], v[48:51]
    s_waitcnt lgkmcnt(0)
    v_and_b32 v32, v28, v4
    v_and_b32 v33, v28, v5
    v_and_b32 v34, v28, v6
    v_and_b32 v35, v28, v7
    v_and_b32 v36, v29, v4
    v_and_b32 v37, v29, v5
    v_and_b32 v38, v29, v6
    v_and_b32 v39, v29, v7
    v_and_b32 v40, v30, v4
    v_and_b32 v41, v30, v5
    v_and_b32 v42, v30, v6
    v_and_b32 v43, v30, v7
    v_and_b32 v44, v31, v4
    v_and_b32 v45, v31, v5
    v_and_b32 v46, v31, v6
    v_and_b32 v47, v31, v7
    v_mfma_f32_16x16x32_bf16 v[48:51], v[32:35], v[144:147], v[48:51]
    v_mfma_f32_16x16x32_bf16 v[48:51], v[36:39], v[148:151], v[48:51]
    v_mfma_f32_16x16x32_bf16 v[48:51], v[40:43], v[152:155], v[48:51]
    v_mfma_f32_16x16x32_bf16 v[48:51], v[44:47], v[156:159], v[48:51]
    s_nop 7
    v_mov_b32 v16, v48
    v_mov_b32 v17, v49
    v_mov_b32 v18, v50
    v_mov_b32 v19, v51
    v_permlane32_swap_b32 v16, v48
    v_permlane32_swap_b32 v17, v49
    v_permlane32_swap_b32 v18, v50
    v_permlane32_swap_b32 v19, v51
    v_add_f32_dpp v16, v48, v16 row_ror:8 row_mask:0xf bank_mask:0xf
    v_add_f32_dpp v17, v49, v17 row_ror:8 row_mask:0xf bank_mask:0xf
    v_add_f32_dpp v18, v50, v18 row_ror:8 row_mask:0xf bank_mask:0xf
    v_add_f32_dpp v19, v51, v19 row_ror:8 row_mask:0xf bank_mask:0xf
    s_mov_b32 s82, 0
    s_mov_b32 s83, -1
    v_and_b32 v8, 7, v0
    v_lshlrev_b32 v8, 6, v8
    v_bfe_u32 v9, v0, 4, 2
    v_lshlrev_b32 v10, 5, v9
    v_and_b32 v10, 32, v10
    v_lshlrev_b32 v9, 3, v9
    v_and_b32 v9, 16, v9
    v_add3_u32 v8, v8, v9, v10
    v_cndmask_b32 v20, v16, v18, s[82:83]
    v_cndmask_b32 v22, v17, v19, s[82:83]
    v_mov_b32 v21, s31
    v_mov_b32 v23, s31
    s_mov_b32 exec_lo, 0x00ff00ff
    s_mov_b32 exec_hi, 0x00ff00ff
    buffer_store_dwordx4 v[20:23], v8, s[52:55], s80 offen sc1
    s_mov_b64 exec, -1
    s_and_b32 s79, s29, 7
    s_cmp_lg_u32 s79, s30
    s_cbranch_scc1 L_fin
    s_mov_b32 s4, 0x100000
    s_mov_b32 s5, 0x101000
    s_mov_b32 s6, 0x102000
    s_mov_b32 s7, 0x103000
    s_mov_b32 s8, 0x104000
    s_mov_b32 s9, 0x105000
    s_mov_b32 s10, 0x106000
    s_mov_b32 s11, 0x107000
    s_mov_b32 s66, 200000
    buffer_load_dwordx2 v[16:17], v57, s[52:55], s4 offen sc1
    buffer_load_dwordx2 v[18:19], v57, s[52:55], s5 offen sc1
    buffer_load_dwordx2 v[20:21], v57, s[52:55], s6 offen sc1
    buffer_load_dwordx2 v[22:23], v57, s[52:55], s7 offen sc1
    buffer_load_dwordx2 v[24:25], v57, s[52:55], s8 offen sc1
    buffer_load_dwordx2 v[26:27], v57, s[52:55], s9 offen sc1
    buffer_load_dwordx2 v[28:29], v57, s[52:55], s10 offen sc1
    buffer_load_dwordx2 v[30:31], v57, s[52:55], s11 offen sc1
L_poll2:
    buffer_load_dwordx2 v[32:33], v57, s[52:55], s4 offen sc1
    buffer_load_dwordx2 v[34:35], v57, s[52:55], s5 offen sc1
    buffer_load_dwordx2 v[36:37], v57, s[52:55], s6 offen sc1
    buffer_load_dwordx2 v[38:39], v57, s[52:55], s7 offen sc1
    buffer_load_dwordx2 v[40:41], v57, s[52:55], s8 offen sc1
    buffer_load_dwordx2 v[42:43], v57, s[52:55], s9 offen sc1
    buffer_load_dwordx2 v[44:45], v57, s[52:55], s10 offen sc1
    buffer_load_dwordx2 v[46:47], v57, s[52:55], s11 offen sc1
    s_waitcnt vmcnt(8)
    v_xor_b32 v17, s31, v17
    v_xor_b32 v19, s31, v19
    v_xor_b32 v21, s31, v21
    v_xor_b32 v23, s31, v23
    v_xor_b32 v25, s31, v25
    v_xor_b32 v27, s31, v27
    v_xor_b32 v29, s31, v29
    v_xor_b32 v31, s31, v31
    v_or3_b32 v17, v17, v19, v21
    v_or3_b32 v23, v23, v25, v27
    v_or3_b32 v17, v17, v29, v31
    v_or_b32 v17, v17, v23
    v_cmp_ne_u32 vcc, 0, v17
    s_nop 1
    s_cmp_lg_u64 vcc, 0
    s_cbranch_scc0 L_got2a
    buffer_load_dwordx2 v[16:17], v57, s[52:55], s4 offen sc1
    buffer_load_dwordx2 v[18:19], v57, s[52:55], s5 offen sc1
    buffer_load_dwordx2 v[20:21], v57, s[52:55], s6 offen sc1
    buffer_load_dwordx2 v[22:23], v57, s[52:55], s7 offen sc1
    buffer_load_dwordx2 v[24:25], v57, s[52:55], s8 offen sc1
    buffer_load_dwordx2 v[26:27], v57, s[52:55], s9 offen sc1
    buffer_load_dwordx2 v[28:29], v57, s[52:55], s10 offen sc1
    buffer_load_dwordx2 v[30:31], v57, s[52:55], s11 offen sc1
    s_waitcnt vmcnt(8)
    v_xor_b32 v33, s31, v33
    v_xor_b32 v35, s31, v35
    v_xor_b32 v37, s31, v37
    v_xor_b32 v39, s31, v39
    v_xor_b32 v41, s31, v41
    v_xor_b32 v43, s31, v43
    v_xor_b32 v45, s31, v45
    v_xor_b32 v47, s31, v47
    v_or3_b32 v33, v33, v35, v37
    v_or3_b32 v39, v39, v41, v43
    v_or3_b32 v33, v33, v45, v47
    v_or_b32 v33, v33, v39
    v_cmp_ne_u32 vcc, 0, v33
    s_nop 1
    s_cmp_lg_u64 vcc, 0
    s_cbranch_scc0 L_got2b
    s_sub_u32 s66, s66, 1
    s_cmp_lg_u32 s66, 0
    s_cbranch_scc1 L_poll2
L_got2b:
    v_add_f32 v60, v32, v34
    v_add_f32 v61, v36, v38
    v_add_f32 v62, v40, v42
    v_add_f32 v63, v44, v46
    v_add_f32 v60, v60, v61
    v_add_f32 v62, v62, v63
    v_add_f32 v60, v60, v62
    s_branch L_got2
L_got2a:
    s_nop 1
    v_add_f32 v60, v16, v18
    v_add_f32 v61, v20, v22
    v_add_f32 v62, v24, v26
    v_add_f32 v63, v28, v30
    v_add_f32 v60, v60, v61
    v_add_f32 v62, v62, v63
    v_add_f32 v60, v60, v62
L_got2:
    v_mov_b32 v61, v60
    s_nop 1
    v_permlane16_swap_b32 v61, v60
    v_add_f32 v60, v60, v61
    v_mov_b32 v61, v60
    s_nop 1
    v_permlane32_swap_b32 v61, v60
    v_add_f32 v60, v60, v61
    v_lshlrev_b32 v58, 16, v58
    v_add_f32 v60, v58, v60
    v_cvt_pk_bf16_f32 v60, v60, v60
    s_mov_b64 exec, 0xffff
    buffer_store_short v60, v56, s[56:59], 0 offen
    s_or_b32 s79, s30, s29
    s_cmp_lg_u32 s79, 0
    s_cbranch_scc1 L_fin
    s_mov_b64 exec, 1
    v_mov_b32 v8, 4
    v_mov_b32 v9, s31
    buffer_store_dword v9, v8, s[52:55], 0 offen sc1
L_fin:
    s_endpgm
L_end:
    s_endpgm

.section .rodata,"a"
.p2align 6
.amdhsa_kernel parallel_sum__mha_block_cached__geglu_ffn__decode_kernel
  .amdhsa_next_free_vgpr 256
  .amdhsa_next_free_sgpr 102
  .amdhsa_accum_offset 256
  .amdhsa_group_segment_fixed_size 0
  .amdhsa_kernarg_size 96
  .amdhsa_user_sgpr_count 2
  .amdhsa_user_sgpr_kernarg_segment_ptr 1
  .amdhsa_system_sgpr_workgroup_id_x 1
  .amdhsa_float_denorm_mode_32 3
.end_amdhsa_kernel
```
